```python
import torch

def _softmax(x, axis=-1):
    return torch.softmax(x, dim=axis)
def _gelu(x):
    return torch.nn.functional.gelu(x, approximate="tanh")
def _silu(x):
    return torch.nn.functional.silu(x)
def _sigmoid(x):
    return torch.sigmoid(x)
def _layernorm(x, axis=-1, eps=1e-5):
    m = x.mean(dim=axis, keepdim=True)
    v = x.var(dim=axis, keepdim=True, unbiased=False)
    return (x - m) / torch.sqrt(v + eps)
def _scatter_add(tgt, idx, src, axis=0):
    return tgt.clone().index_add_(axis, idx, src)
def _segment_sum(src, seg, n):
    out = torch.zeros((n,) + src.shape[1:], dtype=src.dtype)
    return out.index_add_(0, seg, src)
def _pad(x, pw):
    flat = tuple(v for pair in reversed(pw) for v in pair)
    return torch.nn.functional.pad(x, flat)

kernel_name = 'sequential_preLN__ssm_conv_s4__glu_gated_glu__prompt'

def setup_inputs():

    _w = (lambda a: (lambda t: t.to(torch.bfloat16) if t.is_floating_point() else t)(torch.as_tensor(a)))
    def _A_setup():
        B, L, D, N = 1, 2048, 448, 256
        A_re = -(lambda _x: torch.exp(torch.as_tensor(_x)))((lambda *s: torch.randn(*s, dtype=torch.bfloat16) * 3.2)(D, N))
        A_im = torch.pi * (lambda *s: torch.randn(*s, dtype=torch.bfloat16) * 0.05)(D, N)
        B_re = (lambda *s: torch.randn(*s, dtype=torch.bfloat16) * 0.05)(D, N)
        B_im = (lambda *s: torch.randn(*s, dtype=torch.bfloat16) * 0.05)(D, N)
        C_re = (lambda *s: torch.randn(*s, dtype=torch.bfloat16) * 0.05)(D, N)
        C_im = (lambda *s: torch.randn(*s, dtype=torch.bfloat16) * 0.05)(D, N)
        log_dt = (lambda *s: torch.randn(*s, dtype=torch.bfloat16) * 0.05)(D) * 0.5 - 4.0
        Dskip = (lambda *s: torch.randn(*s, dtype=torch.bfloat16) * 0.05)(D)
        return {
            "u": _w((lambda *s: torch.randn(*s, dtype=torch.bfloat16) * 0.05)(B, L, D)),
            "A_re": _w(A_re),
            "A_im": _w(A_im),
            "B_re": _w(B_re),
            "B_im": _w(B_im),
            "C_re": _w(C_re),
            "C_im": _w(C_im),
            "log_dt": _w(log_dt),
            "Dskip": _w(Dskip),
        }
    _A_in = _A_setup()

    def _B_setup():
        B, S, D, F = 1, 2048, 448, 1792
        return {
            "x": _w((lambda *s: torch.randn(*s, dtype=torch.bfloat16) * 0.05)(B, S, D)),
            "w_gate": _w((lambda *s: torch.randn(*s, dtype=torch.bfloat16) * 0.05)(D, F)),
            "w_up": _w((lambda *s: torch.randn(*s, dtype=torch.bfloat16) * 0.05)(D, F)),
            "w_down": _w((lambda *s: torch.randn(*s, dtype=torch.bfloat16) * 0.05)(F, D)),
        }
    _B_in = _B_setup()

    return {
        "A_u": _A_in["u"],
        "A_A_re": _A_in["A_re"],
        "A_A_im": _A_in["A_im"],
        "A_B_re": _A_in["B_re"],
        "A_B_im": _A_in["B_im"],
        "A_C_re": _A_in["C_re"],
        "A_C_im": _A_in["C_im"],
        "A_log_dt": _A_in["log_dt"],
        "A_Dskip": _A_in["Dskip"],
        "B_x": _B_in["x"],
        "B_w_gate": _B_in["w_gate"],
        "B_w_up": _B_in["w_up"],
        "B_w_down": _B_in["w_down"],
    }

def reference(A_u, A_A_re, A_A_im, A_B_re, A_B_im, A_C_re, A_C_im, A_log_dt, A_Dskip, B_x, B_w_gate, B_w_up, B_w_down):
    def _A_ref(u, A_re, A_im, B_re, B_im, C_re, C_im, log_dt, Dskip):
        Bsz, L, D = u.shape
        dt = torch.exp(log_dt)[:, None]
        A = A_re + 1j * A_im
        Bc = B_re + 1j * B_im
        Cc = C_re + 1j * C_im
        logdA = dt * A
        dB = dt * Bc
        l = (lambda x, dt: x.to(dt))(torch.arange(L), A_re.dtype)
        P = torch.exp(logdA[:, :, None] * l[None, None, :])
        K = torch.einsum("dn,dnl,dn->dl", Cc, P, dB).real
        L2 = 2 * L
        Kp = _pad(K, ((0, 0), (0, L)))
        up = (lambda x, *d: x.permute(*d))(u, 0, 2, 1)
        up = _pad(up, ((0, 0), (0, 0), (0, L)))
        Kf = (lambda x, axes=(-2,-1): torch.fft.rfft2(x.float(), dim=axes))(Kp[:, None, :], axes=(-2, -1))
        Uf = (lambda x, axes=(-2,-1): torch.fft.rfft2(x.float(), dim=axes))(up[:, :, None, :], axes=(-2, -1))
        Yf = Uf * Kf[None, :, :, :]
        y = (lambda x, s, axes=(-2,-1): torch.fft.irfft2(x, s=s, dim=axes).to(torch.bfloat16))(Yf, (1, L2), axes=(-2, -1))[:, :, 0, :L]
        y = (lambda x, *d: x.permute(*d))(y, 0, 2, 1) + u * Dskip[None, None, :]
        return y

    def _B_ref(x, w_gate, w_up, w_down):
        g = torch.einsum("bsd,df->bsf", x, w_gate)
        u = torch.einsum("bsd,df->bsf", x, w_up)
        h = _sigmoid(g) * u
        return torch.einsum("bsf,fd->bsd", h, w_down)

    x = A_u
    h = x + _A_ref(_layernorm(x, axis=-1), A_A_re, A_A_im, A_B_re, A_B_im, A_C_re, A_C_im, A_log_dt, A_Dskip)
    h2 = h + _B_ref(_layernorm(h, axis=-1), B_w_gate, B_w_up, B_w_down)
    return h2
```

```asm
; @launch kernel=ssm_kernel grid=(256,1,1) block=(512,1,1) lds=160768
; @launch kernel=ffn_kernel grid=(256,1,1) block=(256,1,1) lds=150528
.amdgcn_target "amdgcn-amd-amdhsa--gfx950"
.text
.globl ssm_kernel
.p2align 8
.type ssm_kernel,@function
ssm_kernel:
s_cmp_ge_u32 s2, 256
s_cbranch_scc1 LA_end
s_load_dwordx16 s[8:23], s[0:1], 0
s_load_dwordx2 s[24:25], s[0:1], 64
s_load_dwordx4 s[28:31], s[0:1], 80
s_load_dwordx2 s[26:27], s[0:1], 96
s_load_dwordx4 s[32:35], s[0:1], 112
v_lshrrev_b32 v3, 6, v0
v_and_b32 v0, 63, v0
v_readfirstlane_b32 s3, v3
s_and_b32 s89, s2, 7
s_lshr_b32 s90, s2, 3
s_getpc_b64 s[52:53]
LPF_ab:
s_sub_u32 s52, s52, LPF_ab - ssm_kernel
s_subb_u32 s53, s53, 0
s_mul_i32 s54, s90, 8
s_add_u32 s54, s54, s3
s_lshl_b32 s54, s54, 10
s_cmp_ge_u32 s54, code_end - ssm_kernel
s_cbranch_scc1 LPFX_ab
v_lshlrev_b32 v240, 4, v0
v_add_u32 v240, s54, v240
v_min_u32 v240, code_end - ssm_kernel - 16, v240
global_load_dwordx4 v[244:247], v240, s[52:53]
LPFX_ab:
s_mul_i32 s84, s89, 28
s_add_u32 s84, s84, s90
s_lshl_b32 s95, s89, 2
s_add_u32 s95, s95, s90
s_sub_u32 s95, s95, 28
s_lshr_b32 s85, s3, 1
s_and_b32 s85, s85, 1
s_and_b32 s86, s3, 1
v_mov_b32 v250, 0
v_mov_b32 v251, 0
s_xor_b32 s91, s3, 4
s_cmp_lt_u32 s90, 28
s_cselect_b32 s3, s91, s3
s_lshl_b32 s91, s84, 1
s_add_u32 s91, s91, s85
s_lshl_b32 s92, s91, 9
s_lshl_b32 s93, s86, 8
s_add_u32 s92, s92, s93
v_lshlrev_b32 v6, 2, v0
s_mul_i32 s96, s84, 9363
s_lshr_b32 s96, s96, 16
s_mul_i32 s97, s96, 7
s_sub_u32 s97, s84, s97
s_mul_i32 s96, s96, 57344
s_lshl_b32 s97, s97, 7
s_add_u32 s96, s96, s97
s_and_b32 s97, s3, 3
s_lshl_b32 s97, s97, 3
v_lshrrev_b32 v21, 3, v0
v_add_u32 v21, s97, v21
v_mul_u32_u24 v21, 896, v21
v_and_b32 v4, 7, v0
v_lshlrev_b32 v4, 4, v4
v_add_u32 v21, v21, v4
s_add_u32 s97, s96, 28672
s_lshl_b32 s94, s84, 2
s_waitcnt lgkmcnt(0)
s_mov_b32 s36, s8
s_mov_b32 s37, s9
s_mov_b32 s38, 1835008
s_mov_b32 s39, 0x00020000
s_mov_b32 s40, s34
s_mov_b32 s41, s35
s_mov_b32 s42, 22806528
s_mov_b32 s43, 0x00020000
s_cmp_ge_u32 s90, 28
s_cbranch_scc0 LA_conv
buffer_load_dword v2, off, s[40:43], 0 sc1
s_cmp_ge_u32 s3, 4
s_cbranch_scc1 LA_spare
v_mov_b32 v8, 0
v_mov_b32 v168, 0
v_mov_b32 v9, 0
v_mov_b32 v169, 0
v_mov_b32 v10, 0
v_mov_b32 v170, 0
v_mov_b32 v11, 0
v_mov_b32 v171, 0
s_lshl_b32 s91, s2, 3
s_sub_u32 s93, s3, 0
s_lshl_b32 s93, s93, 1
s_add_u32 s91, s91, s93
s_mul_i32 s91, s91, 896
v_lshlrev_b32 v4, 4, v0
s_mov_b32 exec_hi, 0x00ffffff
buffer_load_dwordx4 v[8:11], v4, s[36:39], s91 offen
buffer_load_dwordx4 v[168:171], v4, s[36:39], s91 offen offset:896
s_mov_b32 exec_hi, -1
s_lshl_b32 s89, s2, 6
s_add_u32 s89, s89, 4096
s_mov_b64 exec, 1
buffer_load_dword v248, v251, s[40:43], s89 offen sc1
s_mov_b64 exec, -1
s_branch LA_spare
LA_conv:
s_load_dword s87, s[22:23], s94
s_load_dword s88, s[24:25], s94
s_cmp_ge_u32 s3, 4
s_cbranch_scc0 LA_mloads
buffer_load_dwordx4 v[172:175], v21, s[36:39], s96 offen
buffer_load_dwordx4 v[176:179], v21, s[36:39], s97 offen
buffer_load_dword v2, off, s[40:43], 0 sc1
v_mov_b32 v20, v6
v_mov_b32 v8, 0
v_mov_b32 v168, 0
v_mov_b32 v9, 0
v_mov_b32 v169, 0
v_mov_b32 v10, 0
v_mov_b32 v170, 0
v_mov_b32 v11, 0
v_mov_b32 v171, 0
s_lshl_b32 s91, s2, 3
s_sub_u32 s93, s3, 4
s_lshl_b32 s93, s93, 1
s_add_u32 s91, s91, s93
s_mul_i32 s91, s91, 896
v_lshlrev_b32 v4, 4, v0
s_mov_b32 exec_hi, 0x00ffffff
buffer_load_dwordx4 v[8:11], v4, s[36:39], s91 offen
buffer_load_dwordx4 v[168:171], v4, s[36:39], s91 offen offset:896
s_mov_b32 exec_hi, -1
s_lshl_b32 s89, s2, 6
s_add_u32 s89, s89, 4096
s_mov_b64 exec, 1
buffer_load_dword v248, v251, s[40:43], s89 offen sc1
s_mov_b64 exec, -1
s_mov_b32 s44, s10
s_mov_b32 s45, s11
s_mov_b32 s46, 229376
s_mov_b32 s47, 0x00020000
s_mov_b32 s48, s12
s_mov_b32 s49, s13
s_mov_b32 s50, 229376
s_mov_b32 s51, 0x00020000
buffer_load_dword v16, v20, s[44:47], s92 offen
buffer_load_dword v17, v20, s[48:51], s92 offen
s_lshl_b32 s52, s84, 2
s_add_u32 s52, s52, s3
s_sub_u32 s52, s52, 4
s_min_u32 s89, s52, 783
s_mul_i32 s53, s89, 2341
s_lshr_b32 s53, s53, 16
s_mul_i32 s54, s53, 28
s_sub_u32 s54, s89, s54
s_mul_i32 s55, s89, 9363
s_lshr_b32 s55, s55, 16
s_mul_i32 s56, s55, 7
s_sub_u32 s56, s89, s56
s_sub_u32 s57, s3, 4
s_mul_i32 s57, s57, 6144
s_add_u32 s57, s57, 33792
s_mov_b32 s68, s28
s_mov_b32 s69, s29
s_mov_b32 s70, 1605632
s_mov_b32 s71, 0x00020000
s_mov_b32 s72, s30
s_mov_b32 s73, s31
s_mov_b32 s74, 1605632
s_mov_b32 s75, 0x00020000
s_mov_b32 s76, s26
s_mov_b32 s77, s27
s_mov_b32 s78, 1605632
s_mov_b32 s79, 0x00020000
s_waitcnt vmcnt(6)
s_sub_u32 s93, s3, 4
s_lshl_b32 s93, s93, 3
v_lshrrev_b32 v3, 3, v0
v_add_u32 v3, s93, v3
v_mul_u32_u24 v3, 144, v3
v_and_b32 v4, 7, v0
v_lshlrev_b32 v4, 4, v4
v_add_u32 v3, v3, v4
v_add_u32 v3, 135168, v3
ds_write_b128 v3, v[172:175]
ds_write_b128 v3, v[176:179] offset:4608
s_waitcnt lgkmcnt(0)
s_barrier
s_branch LA_nwave
LA_mloads:
buffer_load_dword v2, off, s[40:43], 0 sc1
s_mov_b32 s44, s10
s_mov_b32 s45, s11
s_mov_b32 s46, 229376
s_mov_b32 s47, 0x00020000
buffer_load_dword v16, v6, s[44:47], s92 offen
s_mov_b32 s48, s12
s_mov_b32 s49, s13
s_mov_b32 s50, 229376
s_mov_b32 s51, 0x00020000
buffer_load_dword v17, v6, s[48:51], s92 offen
s_mov_b32 s52, s14
s_mov_b32 s53, s15
s_mov_b32 s54, 229376
s_mov_b32 s55, 0x00020000
buffer_load_dword v18, v6, s[52:55], s92 offen
s_mov_b32 s56, s16
s_mov_b32 s57, s17
s_mov_b32 s58, 229376
s_mov_b32 s59, 0x00020000
buffer_load_dword v19, v6, s[56:59], s92 offen
s_mov_b32 s60, s18
s_mov_b32 s61, s19
s_mov_b32 s62, 229376
s_mov_b32 s63, 0x00020000
buffer_load_dword v20, v6, s[60:63], s92 offen
s_mov_b32 s64, s20
s_mov_b32 s65, s21
s_mov_b32 s66, 229376
s_mov_b32 s67, 0x00020000
buffer_load_dword v21, v6, s[64:67], s92 offen
v_and_b32 v213, 15, v0
v_lshrrev_b32 v214, 4, v0
v_and_b32 v3, 1, v213
v_add_u32 v4, v213, v3
v_mul_u32_u24 v3, 4160, v3
v_lshlrev_b32 v4, 1, v4
v_sub_u32 v3, v3, v4
v_lshlrev_b32 v4, 4, v214
v_add_u32 v3, v3, v4
s_mul_i32 s90, s85, 8320
s_lshl_b32 s91, s86, 6
s_sub_u32 s90, s90, s91
s_add_u32 s90, s90, 4064
s_sub_u32 s92, s90, 896
v_add_u32 v208, s92, v3
s_sub_u32 s92, s90, 1920
v_add_u32 v209, s92, v3
s_sub_u32 s92, s90, 2944
v_add_u32 v210, s92, v3
s_sub_u32 s92, s90, 3968
v_add_u32 v211, s92, v3
v_lshlrev_b32 v3, 5, v213
v_lshlrev_b32 v4, 4, v214
v_add_u32 v3, v3, v4
s_mul_i32 s90, s85, 4608
s_sub_u32 s90, s90, s91
s_add_u32 s90, s90, 135264
v_add_u32 v212, s90, v3
s_lshl_b32 s90, s3, 12
s_add_u32 s90, s90, 17408
v_lshlrev_b32 v215, 4, v0
v_add_u32 v215, s90, v215
s_xor_b32 s90, s3, 1
s_lshl_b32 s90, s90, 12
s_add_u32 s90, s90, 17408
v_lshlrev_b32 v220, 4, v0
v_add_u32 v220, s90, v220
v_lshlrev_b32 v3, 5, v213
v_lshlrev_b32 v4, 3, v214
v_add_u32 v3, v3, v4
s_lshl_b32 s91, s86, 11
s_mul_i32 s90, s85, 4608
s_add_u32 s90, s90, s91
s_add_u32 s90, s90, 135680
v_add_u32 v216, s90, v3
s_lshl_b32 s90, s85, 12
s_add_u32 s90, s90, s91
s_add_u32 s90, s90, 144384
v_add_u32 v217, s90, v3
s_lshl_b32 s90, s84, 1
s_add_u32 s90, s90, s85
s_lshl_b32 s90, s90, 6
s_mul_i32 s91, s86, 917504
s_add_u32 s90, s90, s91
s_add_u32 s66, s90, 65536
v_lshrrev_b32 v219, 1, v213
v_mul_u32_u24 v219, 28672, v219
v_and_b32 v4, 1, v213
v_lshlrev_b32 v4, 5, v4
v_add_u32 v219, v219, v4
v_lshlrev_b32 v4, 3, v214
v_add_u32 v219, v219, v4
s_waitcnt vmcnt(6)
s_mov_b32 s89, 0x9E3779B1
v_mul_lo_u32 v1, v2, s89
v_add_u32 v1, 0x7F4A7C15, v1
s_waitcnt lgkmcnt(0)
s_lshl_b32 s90, s88, 16
s_and_b32 s91, s88, 0xffff0000
s_cmp_eq_u32 s85, 0
s_cselect_b32 s67, s90, s91
s_barrier
v_lshrrev_b32 v3, 4, v0
v_lshlrev_b32 v3, 2, v3
v_bfe_u32 v4, v0, 2, 2
v_add_u32 v3, v3, v4
v_mul_u32_u24 v3, 144, v3
v_and_b32 v4, 3, v0
v_lshlrev_b32 v4, 3, v4
v_add_u32 v3, v3, v4
s_sub_u32 s93, s3, 0
s_lshl_b32 s89, s93, 5
s_add_u32 s89, s89, 135168
v_add_u32 v3, s89, v3
ds_read_b64_tr_b16 v[172:173], v3 offset:0
ds_read_b64_tr_b16 v[174:175], v3 offset:2304
ds_read_b64_tr_b16 v[176:177], v3 offset:4608
ds_read_b64_tr_b16 v[178:179], v3 offset:6912
v_and_b32 v4, 15, v0
v_mul_u32_u24 v4, 144, v4
v_lshrrev_b32 v6, 4, v0
v_lshlrev_b32 v6, 3, v6
v_add_u32 v4, v4, v6
s_mul_i32 s89, s93, 2304
s_add_u32 s89, s89, 144384
v_add_u32 v4, s89, v4
v_lshrrev_b32 v6, 3, v0
v_mul_u32_u24 v6, 144, v6
v_and_b32 v7, 7, v0
v_lshlrev_b32 v7, 4, v7
v_add_u32 v6, v6, v7
v_add_u32 v6, s89, v6
s_waitcnt lgkmcnt(3)
ds_write_b64 v4, v[172:173] offset:0
s_waitcnt lgkmcnt(3)
ds_write_b64 v4, v[174:175] offset:32
s_waitcnt lgkmcnt(3)
ds_write_b64 v4, v[176:177] offset:64
s_waitcnt lgkmcnt(3)
ds_write_b64 v4, v[178:179] offset:96
s_mul_i32 s89, s84, 9363
s_lshr_b32 s89, s89, 16
s_mul_i32 s90, s89, 7
s_sub_u32 s90, s84, s90
s_lshl_b32 s90, s90, 5
s_add_u32 s89, s89, s90
s_lshl_b32 s89, s89, 13
s_lshl_b32 s90, s93, 11
s_add_u32 s89, s89, s90
s_add_u32 s90, s89, 20971520
s_add_u32 s89, s89, 18874368
v_lshlrev_b32 v3, 4, v0
s_waitcnt lgkmcnt(0)
ds_read_b128 v[172:175], v6
ds_read_b128 v[176:179], v6 offset:1152
s_waitcnt lgkmcnt(1)
buffer_store_dwordx4 v[172:175], v3, s[40:43], s89 offen offset:0 sc1
v_xor_b32 v184, v172, v1
v_xor_b32 v185, v173, v1
v_xor_b32 v186, v174, v1
v_xor_b32 v187, v175, v1
buffer_store_dwordx4 v[184:187], v3, s[40:43], s90 offen offset:0 sc1
s_waitcnt lgkmcnt(0)
buffer_store_dwordx4 v[176:179], v3, s[40:43], s89 offen offset:1024 sc1
v_xor_b32 v188, v176, v1
v_xor_b32 v189, v177, v1
v_xor_b32 v190, v178, v1
v_xor_b32 v191, v179, v1
buffer_store_dwordx4 v[188:191], v3, s[40:43], s90 offen offset:1024 sc1
s_waitcnt vmcnt(4)
s_waitcnt lgkmcnt(0)
s_cmp_eq_u32 s3, 3
s_cbranch_scc0 LM_noat
s_mov_b32 s80, s32
s_mov_b32 s81, s33
s_mov_b32 s82, 256
s_mov_b32 s83, 0x00020000
s_and_b32 s90, s2, 3
s_lshl_b32 s90, s90, 6
v_mov_b32 v250, 1
v_mov_b32 v251, 0
s_mov_b64 exec, 1
buffer_atomic_add v250, v251, s[80:83], s90 offen sc1
s_mov_b64 exec, -1
LM_noat:
s_lshl_b32 s89, s87, 16
s_and_b32 s90, s87, 0xffff0000
s_cmp_eq_u32 s85, 0
s_cselect_b32 s89, s89, s90
v_mov_b32 v22, s89
v_mul_f32 v22, 0x3fb8aa3b, v22
v_exp_f32 v22, v22
s_nop 0
v_cvt_pk_bf16_f32 v22, v22, v22
v_and_b32 v22, 0xffff0000, v22
v_lshlrev_b32 v24, 16, v16
v_and_b32 v25, 0xffff0000, v16
v_lshlrev_b32 v26, 16, v17
v_and_b32 v27, 0xffff0000, v17
v_lshlrev_b32 v28, 16, v18
v_and_b32 v29, 0xffff0000, v18
v_lshlrev_b32 v30, 16, v19
v_and_b32 v31, 0xffff0000, v19
v_lshlrev_b32 v32, 16, v20
v_and_b32 v33, 0xffff0000, v20
v_lshlrev_b32 v34, 16, v21
v_and_b32 v35, 0xffff0000, v21
v_mul_f32 v24, v22, v24
v_mul_f32 v25, v22, v25
v_mul_f32 v26, v22, v26
v_mul_f32 v27, v22, v27
v_mul_f32 v28, v22, v28
v_mul_f32 v29, v22, v29
v_mul_f32 v30, v22, v30
v_mul_f32 v31, v22, v31
v_mul_f32 v24, 0x3fb8aa3b, v24
v_mul_f32 v25, 0x3fb8aa3b, v25
v_mul_f32 v26, 0x3e22f983, v26
v_mul_f32 v27, 0x3e22f983, v27
v_mul_f32 v36, v32, v28
v_mul_f32 v37, v32, v30
v_fma_f32 v36, -v34, v30, v36
v_fma_f32 v37, v34, v28, v37
v_mul_f32 v38, v33, v29
v_mul_f32 v39, v33, v31
v_fma_f32 v38, -v35, v31, v38
v_fma_f32 v39, v35, v29, v39
v_mul_f32 v96, 1.0, v24
v_mul_f32 v97, 1.0, v26
v_exp_f32 v96, v96
v_fract_f32 v97, v97
s_nop 0
v_cos_f32 v56, v97
v_sin_f32 v57, v97
s_nop 0
v_mul_f32 v56, v96, v56
v_mul_f32 v57, v96, v57
v_mul_f32 v96, 0x43800000, v24
v_mul_f32 v97, 0x43800000, v26
v_exp_f32 v96, v96
v_fract_f32 v97, v97
s_nop 0
v_cos_f32 v68, v97
v_sin_f32 v69, v97
s_nop 0
v_mul_f32 v68, v96, v68
v_mul_f32 v69, v96, v69
v_mul_f32 v98, 1.0, v25
v_mul_f32 v99, 1.0, v27
v_exp_f32 v98, v98
v_fract_f32 v99, v99
s_nop 0
v_cos_f32 v58, v99
v_sin_f32 v59, v99
s_nop 0
v_mul_f32 v58, v98, v58
v_mul_f32 v59, v98, v59
v_mul_f32 v98, 0x43800000, v25
v_mul_f32 v99, 0x43800000, v27
v_exp_f32 v98, v98
v_fract_f32 v99, v99
s_nop 0
v_cos_f32 v70, v99
v_sin_f32 v71, v99
s_nop 0
v_mul_f32 v70, v98, v70
v_mul_f32 v71, v98, v71
s_setprio 1
s_lshl_b32 s89, s85, 1
s_add_u32 s89, s89, s86
s_mul_i32 s89, s89, 16896
v_lshlrev_b32 v108, 3, v0
v_add_u32 v108, s89, v108
v_cvt_pk_bf16_f32 v100, v36, v37
v_cvt_pk_bf16_f32 v101, v38, v39
ds_write_b64 v108, v[100:101] offset:0
v_pk_mul_f32 v[60:61], v[36:37], v[56:57] op_sel_hi:[0,1]
v_pk_mul_f32 v[62:63], v[38:39], v[58:59] op_sel_hi:[0,1]
v_pk_fma_f32 v[60:61], v[36:37], v[56:57], v[60:61] op_sel:[1,1,0] op_sel_hi:[1,0,1] neg_lo:[1,0,0]
v_pk_fma_f32 v[62:63], v[38:39], v[58:59], v[62:63] op_sel:[1,1,0] op_sel_hi:[1,0,1] neg_lo:[1,0,0]
v_cvt_pk_bf16_f32 v102, v60, v61
v_cvt_pk_bf16_f32 v103, v62, v63
ds_write_b64 v108, v[102:103] offset:528
v_pk_mul_f32 v[40:41], v[60:61], v[56:57] op_sel_hi:[0,1]
v_pk_mul_f32 v[42:43], v[62:63], v[58:59] op_sel_hi:[0,1]
v_pk_fma_f32 v[40:41], v[60:61], v[56:57], v[40:41] op_sel:[1,1,0] op_sel_hi:[1,0,1] neg_lo:[1,0,0]
v_pk_fma_f32 v[42:43], v[62:63], v[58:59], v[42:43] op_sel:[1,1,0] op_sel_hi:[1,0,1] neg_lo:[1,0,0]
v_cvt_pk_bf16_f32 v104, v40, v41
v_cvt_pk_bf16_f32 v105, v42, v43
ds_write_b64 v108, v[104:105] offset:1056
v_pk_mul_f32 v[60:61], v[40:41], v[56:57] op_sel_hi:[0,1]
v_pk_mul_f32 v[62:63], v[42:43], v[58:59] op_sel_hi:[0,1]
v_pk_fma_f32 v[60:61], v[40:41], v[56:57], v[60:61] op_sel:[1,1,0] op_sel_hi:[1,0,1] neg_lo:[1,0,0]
v_pk_fma_f32 v[62:63], v[42:43], v[58:59], v[62:63] op_sel:[1,1,0] op_sel_hi:[1,0,1] neg_lo:[1,0,0]
v_cvt_pk_bf16_f32 v106, v60, v61
v_cvt_pk_bf16_f32 v107, v62, v63
ds_write_b64 v108, v[106:107] offset:1584
v_pk_mul_f32 v[44:45], v[60:61], v[56:57] op_sel_hi:[0,1]
v_pk_mul_f32 v[46:47], v[62:63], v[58:59] op_sel_hi:[0,1]
v_pk_fma_f32 v[44:45], v[60:61], v[56:57], v[44:45] op_sel:[1,1,0] op_sel_hi:[1,0,1] neg_lo:[1,0,0]
v_pk_fma_f32 v[46:47], v[62:63], v[58:59], v[46:47] op_sel:[1,1,0] op_sel_hi:[1,0,1] neg_lo:[1,0,0]
v_cvt_pk_bf16_f32 v100, v44, v45
v_cvt_pk_bf16_f32 v101, v46, v47
ds_write_b64 v108, v[100:101] offset:2112
ds_write_b64 v108, v[100:101] offset:4224
v_pk_mul_f32 v[60:61], v[44:45], v[56:57] op_sel_hi:[0,1]
v_pk_mul_f32 v[62:63], v[46:47], v[58:59] op_sel_hi:[0,1]
v_pk_fma_f32 v[60:61], v[44:45], v[56:57], v[60:61] op_sel:[1,1,0] op_sel_hi:[1,0,1] neg_lo:[1,0,0]
v_pk_fma_f32 v[62:63], v[46:47], v[58:59], v[62:63] op_sel:[1,1,0] op_sel_hi:[1,0,1] neg_lo:[1,0,0]
v_cvt_pk_bf16_f32 v102, v60, v61
v_cvt_pk_bf16_f32 v103, v62, v63
ds_write_b64 v108, v[102:103] offset:2640
v_pk_mul_f32 v[48:49], v[60:61], v[56:57] op_sel_hi:[0,1]
v_pk_mul_f32 v[50:51], v[62:63], v[58:59] op_sel_hi:[0,1]
v_pk_fma_f32 v[48:49], v[60:61], v[56:57], v[48:49] op_sel:[1,1,0] op_sel_hi:[1,0,1] neg_lo:[1,0,0]
v_pk_fma_f32 v[50:51], v[62:63], v[58:59], v[50:51] op_sel:[1,1,0] op_sel_hi:[1,0,1] neg_lo:[1,0,0]
v_cvt_pk_bf16_f32 v104, v48, v49
v_cvt_pk_bf16_f32 v105, v50, v51
ds_write_b64 v108, v[104:105] offset:3168
v_pk_mul_f32 v[60:61], v[48:49], v[56:57] op_sel_hi:[0,1]
v_pk_mul_f32 v[62:63], v[50:51], v[58:59] op_sel_hi:[0,1]
v_pk_fma_f32 v[60:61], v[48:49], v[56:57], v[60:61] op_sel:[1,1,0] op_sel_hi:[1,0,1] neg_lo:[1,0,0]
v_pk_fma_f32 v[62:63], v[50:51], v[58:59], v[62:63] op_sel:[1,1,0] op_sel_hi:[1,0,1] neg_lo:[1,0,0]
v_cvt_pk_bf16_f32 v106, v60, v61
v_cvt_pk_bf16_f32 v107, v62, v63
ds_write_b64 v108, v[106:107] offset:3696
v_pk_mul_f32 v[52:53], v[60:61], v[56:57] op_sel_hi:[0,1]
v_pk_mul_f32 v[54:55], v[62:63], v[58:59] op_sel_hi:[0,1]
v_pk_fma_f32 v[52:53], v[60:61], v[56:57], v[52:53] op_sel:[1,1,0] op_sel_hi:[1,0,1] neg_lo:[1,0,0]
v_pk_fma_f32 v[54:55], v[62:63], v[58:59], v[54:55] op_sel:[1,1,0] op_sel_hi:[1,0,1] neg_lo:[1,0,0]
v_cvt_pk_bf16_f32 v100, v52, v53
v_cvt_pk_bf16_f32 v101, v54, v55
ds_write_b64 v108, v[100:101] offset:6336
v_pk_mul_f32 v[72:73], v[68:69], v[68:69] op_sel_hi:[0,1]
v_pk_mul_f32 v[74:75], v[70:71], v[70:71] op_sel_hi:[0,1]
v_pk_fma_f32 v[72:73], v[68:69], v[68:69], v[72:73] op_sel:[1,1,0] op_sel_hi:[1,0,1] neg_lo:[1,0,0]
v_pk_fma_f32 v[74:75], v[70:71], v[70:71], v[74:75] op_sel:[1,1,0] op_sel_hi:[1,0,1] neg_lo:[1,0,0]
v_pk_mul_f32 v[76:77], v[72:73], v[68:69] op_sel_hi:[0,1]
v_pk_mul_f32 v[78:79], v[74:75], v[70:71] op_sel_hi:[0,1]
v_pk_fma_f32 v[76:77], v[72:73], v[68:69], v[76:77] op_sel:[1,1,0] op_sel_hi:[1,0,1] neg_lo:[1,0,0]
v_pk_fma_f32 v[78:79], v[74:75], v[70:71], v[78:79] op_sel:[1,1,0] op_sel_hi:[1,0,1] neg_lo:[1,0,0]
v_pk_mul_f32 v[80:81], v[72:73], v[72:73] op_sel_hi:[0,1]
v_pk_mul_f32 v[82:83], v[74:75], v[74:75] op_sel_hi:[0,1]
v_pk_fma_f32 v[80:81], v[72:73], v[72:73], v[80:81] op_sel:[1,1,0] op_sel_hi:[1,0,1] neg_lo:[1,0,0]
v_pk_fma_f32 v[82:83], v[74:75], v[74:75], v[82:83] op_sel:[1,1,0] op_sel_hi:[1,0,1] neg_lo:[1,0,0]
v_pk_mul_f32 v[84:85], v[80:81], v[68:69] op_sel_hi:[0,1]
v_pk_mul_f32 v[86:87], v[82:83], v[70:71] op_sel_hi:[0,1]
v_pk_fma_f32 v[84:85], v[80:81], v[68:69], v[84:85] op_sel:[1,1,0] op_sel_hi:[1,0,1] neg_lo:[1,0,0]
v_pk_fma_f32 v[86:87], v[82:83], v[70:71], v[86:87] op_sel:[1,1,0] op_sel_hi:[1,0,1] neg_lo:[1,0,0]
v_pk_mul_f32 v[88:89], v[80:81], v[72:73] op_sel_hi:[0,1]
v_pk_mul_f32 v[90:91], v[82:83], v[74:75] op_sel_hi:[0,1]
v_pk_fma_f32 v[88:89], v[80:81], v[72:73], v[88:89] op_sel:[1,1,0] op_sel_hi:[1,0,1] neg_lo:[1,0,0]
v_pk_fma_f32 v[90:91], v[82:83], v[74:75], v[90:91] op_sel:[1,1,0] op_sel_hi:[1,0,1] neg_lo:[1,0,0]
v_pk_mul_f32 v[92:93], v[80:81], v[76:77] op_sel_hi:[0,1]
v_pk_mul_f32 v[94:95], v[82:83], v[78:79] op_sel_hi:[0,1]
v_pk_fma_f32 v[92:93], v[80:81], v[76:77], v[92:93] op_sel:[1,1,0] op_sel_hi:[1,0,1] neg_lo:[1,0,0]
v_pk_fma_f32 v[94:95], v[82:83], v[78:79], v[94:95] op_sel:[1,1,0] op_sel_hi:[1,0,1] neg_lo:[1,0,0]
v_pk_mul_f32 v[60:61], v[36:37], v[68:69] op_sel_hi:[0,1]
v_pk_mul_f32 v[62:63], v[38:39], v[70:71] op_sel_hi:[0,1]
v_pk_fma_f32 v[60:61], v[36:37], v[68:69], v[60:61] op_sel:[1,1,0] op_sel_hi:[1,0,1] neg_lo:[1,0,0]
v_pk_fma_f32 v[62:63], v[38:39], v[70:71], v[62:63] op_sel:[1,1,0] op_sel_hi:[1,0,1] neg_lo:[1,0,0]
v_cvt_pk_bf16_f32 v102, v60, v61
v_cvt_pk_bf16_f32 v103, v62, v63
ds_write_b64 v108, v[102:103] offset:4752
v_pk_mul_f32 v[64:65], v[40:41], v[68:69] op_sel_hi:[0,1]
v_pk_mul_f32 v[66:67], v[42:43], v[70:71] op_sel_hi:[0,1]
v_pk_fma_f32 v[64:65], v[40:41], v[68:69], v[64:65] op_sel:[1,1,0] op_sel_hi:[1,0,1] neg_lo:[1,0,0]
v_pk_fma_f32 v[66:67], v[42:43], v[70:71], v[66:67] op_sel:[1,1,0] op_sel_hi:[1,0,1] neg_lo:[1,0,0]
v_cvt_pk_bf16_f32 v104, v64, v65
v_cvt_pk_bf16_f32 v105, v66, v67
ds_write_b64 v108, v[104:105] offset:5280
v_pk_mul_f32 v[60:61], v[44:45], v[68:69] op_sel_hi:[0,1]
v_pk_mul_f32 v[62:63], v[46:47], v[70:71] op_sel_hi:[0,1]
v_pk_fma_f32 v[60:61], v[44:45], v[68:69], v[60:61] op_sel:[1,1,0] op_sel_hi:[1,0,1] neg_lo:[1,0,0]
v_pk_fma_f32 v[62:63], v[46:47], v[70:71], v[62:63] op_sel:[1,1,0] op_sel_hi:[1,0,1] neg_lo:[1,0,0]
v_cvt_pk_bf16_f32 v106, v60, v61
v_cvt_pk_bf16_f32 v107, v62, v63
ds_write_b64 v108, v[106:107] offset:5808
ds_write_b64 v108, v[106:107] offset:6864
v_pk_mul_f32 v[64:65], v[48:49], v[68:69] op_sel_hi:[0,1]
v_pk_mul_f32 v[66:67], v[50:51], v[70:71] op_sel_hi:[0,1]
v_pk_fma_f32 v[64:65], v[48:49], v[68:69], v[64:65] op_sel:[1,1,0] op_sel_hi:[1,0,1] neg_lo:[1,0,0]
v_pk_fma_f32 v[66:67], v[50:51], v[70:71], v[66:67] op_sel:[1,1,0] op_sel_hi:[1,0,1] neg_lo:[1,0,0]
v_cvt_pk_bf16_f32 v100, v64, v65
v_cvt_pk_bf16_f32 v101, v66, v67
ds_write_b64 v108, v[100:101] offset:7392
v_pk_mul_f32 v[60:61], v[52:53], v[68:69] op_sel_hi:[0,1]
v_pk_mul_f32 v[62:63], v[54:55], v[70:71] op_sel_hi:[0,1]
v_pk_fma_f32 v[60:61], v[52:53], v[68:69], v[60:61] op_sel:[1,1,0] op_sel_hi:[1,0,1] neg_lo:[1,0,0]
v_pk_fma_f32 v[62:63], v[54:55], v[70:71], v[62:63] op_sel:[1,1,0] op_sel_hi:[1,0,1] neg_lo:[1,0,0]
v_cvt_pk_bf16_f32 v102, v60, v61
v_cvt_pk_bf16_f32 v103, v62, v63
ds_write_b64 v108, v[102:103] offset:7920
v_pk_mul_f32 v[64:65], v[36:37], v[72:73] op_sel_hi:[0,1]
v_pk_mul_f32 v[66:67], v[38:39], v[74:75] op_sel_hi:[0,1]
v_pk_fma_f32 v[64:65], v[36:37], v[72:73], v[64:65] op_sel:[1,1,0] op_sel_hi:[1,0,1] neg_lo:[1,0,0]
v_pk_fma_f32 v[66:67], v[38:39], v[74:75], v[66:67] op_sel:[1,1,0] op_sel_hi:[1,0,1] neg_lo:[1,0,0]
v_cvt_pk_bf16_f32 v104, v64, v65
v_cvt_pk_bf16_f32 v105, v66, v67
ds_write_b64 v108, v[104:105] offset:8448
v_pk_mul_f32 v[60:61], v[44:45], v[72:73] op_sel_hi:[0,1]
v_pk_mul_f32 v[62:63], v[46:47], v[74:75] op_sel_hi:[0,1]
v_pk_fma_f32 v[60:61], v[44:45], v[72:73], v[60:61] op_sel:[1,1,0] op_sel_hi:[1,0,1] neg_lo:[1,0,0]
v_pk_fma_f32 v[62:63], v[46:47], v[74:75], v[62:63] op_sel:[1,1,0] op_sel_hi:[1,0,1] neg_lo:[1,0,0]
v_cvt_pk_bf16_f32 v106, v60, v61
v_cvt_pk_bf16_f32 v107, v62, v63
ds_write_b64 v108, v[106:107] offset:8976
v_pk_mul_f32 v[64:65], v[52:53], v[72:73] op_sel_hi:[0,1]
v_pk_mul_f32 v[66:67], v[54:55], v[74:75] op_sel_hi:[0,1]
v_pk_fma_f32 v[64:65], v[52:53], v[72:73], v[64:65] op_sel:[1,1,0] op_sel_hi:[1,0,1] neg_lo:[1,0,0]
v_pk_fma_f32 v[66:67], v[54:55], v[74:75], v[66:67] op_sel:[1,1,0] op_sel_hi:[1,0,1] neg_lo:[1,0,0]
v_cvt_pk_bf16_f32 v100, v64, v65
v_cvt_pk_bf16_f32 v101, v66, v67
ds_write_b64 v108, v[100:101] offset:9504
v_pk_mul_f32 v[60:61], v[36:37], v[76:77] op_sel_hi:[0,1]
v_pk_mul_f32 v[62:63], v[38:39], v[78:79] op_sel_hi:[0,1]
v_pk_fma_f32 v[60:61], v[36:37], v[76:77], v[60:61] op_sel:[1,1,0] op_sel_hi:[1,0,1] neg_lo:[1,0,0]
v_pk_fma_f32 v[62:63], v[38:39], v[78:79], v[62:63] op_sel:[1,1,0] op_sel_hi:[1,0,1] neg_lo:[1,0,0]
v_cvt_pk_bf16_f32 v102, v60, v61
v_cvt_pk_bf16_f32 v103, v62, v63
ds_write_b64 v108, v[102:103] offset:10560
v_pk_mul_f32 v[64:65], v[44:45], v[76:77] op_sel_hi:[0,1]
v_pk_mul_f32 v[66:67], v[46:47], v[78:79] op_sel_hi:[0,1]
v_pk_fma_f32 v[64:65], v[44:45], v[76:77], v[64:65] op_sel:[1,1,0] op_sel_hi:[1,0,1] neg_lo:[1,0,0]
v_pk_fma_f32 v[66:67], v[46:47], v[78:79], v[66:67] op_sel:[1,1,0] op_sel_hi:[1,0,1] neg_lo:[1,0,0]
v_cvt_pk_bf16_f32 v104, v64, v65
v_cvt_pk_bf16_f32 v105, v66, v67
ds_write_b64 v108, v[104:105] offset:11088
v_pk_mul_f32 v[60:61], v[52:53], v[76:77] op_sel_hi:[0,1]
v_pk_mul_f32 v[62:63], v[54:55], v[78:79] op_sel_hi:[0,1]
v_pk_fma_f32 v[60:61], v[52:53], v[76:77], v[60:61] op_sel:[1,1,0] op_sel_hi:[1,0,1] neg_lo:[1,0,0]
v_pk_fma_f32 v[62:63], v[54:55], v[78:79], v[62:63] op_sel:[1,1,0] op_sel_hi:[1,0,1] neg_lo:[1,0,0]
v_cvt_pk_bf16_f32 v106, v60, v61
v_cvt_pk_bf16_f32 v107, v62, v63
ds_write_b64 v108, v[106:107] offset:11616
v_pk_mul_f32 v[64:65], v[36:37], v[80:81] op_sel_hi:[0,1]
v_pk_mul_f32 v[66:67], v[38:39], v[82:83] op_sel_hi:[0,1]
v_pk_fma_f32 v[64:65], v[36:37], v[80:81], v[64:65] op_sel:[1,1,0] op_sel_hi:[1,0,1] neg_lo:[1,0,0]
v_pk_fma_f32 v[66:67], v[38:39], v[82:83], v[66:67] op_sel:[1,1,0] op_sel_hi:[1,0,1] neg_lo:[1,0,0]
v_cvt_pk_bf16_f32 v100, v64, v65
v_cvt_pk_bf16_f32 v101, v66, v67
ds_write_b64 v108, v[100:101] offset:10032
v_pk_mul_f32 v[60:61], v[52:53], v[80:81] op_sel_hi:[0,1]
v_pk_mul_f32 v[62:63], v[54:55], v[82:83] op_sel_hi:[0,1]
v_pk_fma_f32 v[60:61], v[52:53], v[80:81], v[60:61] op_sel:[1,1,0] op_sel_hi:[1,0,1] neg_lo:[1,0,0]
v_pk_fma_f32 v[62:63], v[54:55], v[82:83], v[62:63] op_sel:[1,1,0] op_sel_hi:[1,0,1] neg_lo:[1,0,0]
v_cvt_pk_bf16_f32 v102, v60, v61
v_cvt_pk_bf16_f32 v103, v62, v63
ds_write_b64 v108, v[102:103] offset:12672
v_pk_mul_f32 v[64:65], v[36:37], v[84:85] op_sel_hi:[0,1]
v_pk_mul_f32 v[66:67], v[38:39], v[86:87] op_sel_hi:[0,1]
v_pk_fma_f32 v[64:65], v[36:37], v[84:85], v[64:65] op_sel:[1,1,0] op_sel_hi:[1,0,1] neg_lo:[1,0,0]
v_pk_fma_f32 v[66:67], v[38:39], v[86:87], v[66:67] op_sel:[1,1,0] op_sel_hi:[1,0,1] neg_lo:[1,0,0]
v_cvt_pk_bf16_f32 v104, v64, v65
v_cvt_pk_bf16_f32 v105, v66, v67
ds_write_b64 v108, v[104:105] offset:13200
v_pk_mul_f32 v[60:61], v[52:53], v[84:85] op_sel_hi:[0,1]
v_pk_mul_f32 v[62:63], v[54:55], v[86:87] op_sel_hi:[0,1]
v_pk_fma_f32 v[60:61], v[52:53], v[84:85], v[60:61] op_sel:[1,1,0] op_sel_hi:[1,0,1] neg_lo:[1,0,0]
v_pk_fma_f32 v[62:63], v[54:55], v[86:87], v[62:63] op_sel:[1,1,0] op_sel_hi:[1,0,1] neg_lo:[1,0,0]
v_cvt_pk_bf16_f32 v106, v60, v61
v_cvt_pk_bf16_f32 v107, v62, v63
ds_write_b64 v108, v[106:107] offset:13728
v_pk_mul_f32 v[64:65], v[36:37], v[88:89] op_sel_hi:[0,1]
v_pk_mul_f32 v[66:67], v[38:39], v[90:91] op_sel_hi:[0,1]
v_pk_fma_f32 v[64:65], v[36:37], v[88:89], v[64:65] op_sel:[1,1,0] op_sel_hi:[1,0,1] neg_lo:[1,0,0]
v_pk_fma_f32 v[66:67], v[38:39], v[90:91], v[66:67] op_sel:[1,1,0] op_sel_hi:[1,0,1] neg_lo:[1,0,0]
v_cvt_pk_bf16_f32 v100, v64, v65
v_cvt_pk_bf16_f32 v101, v66, v67
ds_write_b64 v108, v[100:101] offset:12144
v_pk_mul_f32 v[60:61], v[52:53], v[88:89] op_sel_hi:[0,1]
v_pk_mul_f32 v[62:63], v[54:55], v[90:91] op_sel_hi:[0,1]
v_pk_fma_f32 v[60:61], v[52:53], v[88:89], v[60:61] op_sel:[1,1,0] op_sel_hi:[1,0,1] neg_lo:[1,0,0]
v_pk_fma_f32 v[62:63], v[54:55], v[90:91], v[62:63] op_sel:[1,1,0] op_sel_hi:[1,0,1] neg_lo:[1,0,0]
v_cvt_pk_bf16_f32 v102, v60, v61
v_cvt_pk_bf16_f32 v103, v62, v63
ds_write_b64 v108, v[102:103] offset:14784
v_pk_mul_f32 v[64:65], v[36:37], v[92:93] op_sel_hi:[0,1]
v_pk_mul_f32 v[66:67], v[38:39], v[94:95] op_sel_hi:[0,1]
v_pk_fma_f32 v[64:65], v[36:37], v[92:93], v[64:65] op_sel:[1,1,0] op_sel_hi:[1,0,1] neg_lo:[1,0,0]
v_pk_fma_f32 v[66:67], v[38:39], v[94:95], v[66:67] op_sel:[1,1,0] op_sel_hi:[1,0,1] neg_lo:[1,0,0]
v_cvt_pk_bf16_f32 v104, v64, v65
v_cvt_pk_bf16_f32 v105, v66, v67
ds_write_b64 v108, v[104:105] offset:15312
v_pk_mul_f32 v[60:61], v[52:53], v[92:93] op_sel_hi:[0,1]
v_pk_mul_f32 v[62:63], v[54:55], v[94:95] op_sel_hi:[0,1]
v_pk_fma_f32 v[60:61], v[52:53], v[92:93], v[60:61] op_sel:[1,1,0] op_sel_hi:[1,0,1] neg_lo:[1,0,0]
v_pk_fma_f32 v[62:63], v[54:55], v[94:95], v[62:63] op_sel:[1,1,0] op_sel_hi:[1,0,1] neg_lo:[1,0,0]
v_cvt_pk_bf16_f32 v106, v60, v61
v_cvt_pk_bf16_f32 v107, v62, v63
ds_write_b64 v108, v[106:107] offset:15840
v_and_b32 v3, 31, v0
v_mul_u32_u24 v3, 528, v3
v_lshrrev_b32 v4, 5, v0
v_lshlrev_b32 v4, 4, v4
v_add3_u32 v109, v3, v4, s89
v_add_u32 v110, 67584, v109
s_waitcnt lgkmcnt(0)
s_barrier
s_setprio 0
ds_read_b128 v[112:115], v109 offset:0
ds_read_b128 v[116:119], v110 offset:0
ds_read_b128 v[120:123], v109 offset:32
ds_read_b128 v[124:127], v110 offset:32
ds_read_b128 v[128:131], v109 offset:64
ds_read_b128 v[132:135], v110 offset:64
ds_read_b128 v[136:139], v109 offset:96
ds_read_b128 v[140:143], v110 offset:96
s_waitcnt lgkmcnt(6)
v_mfma_f32_32x32x16_bf16 v[16:31], v[112:115], v[116:119], 0
ds_read_b128 v[112:115], v109 offset:128
ds_read_b128 v[116:119], v110 offset:128
s_waitcnt lgkmcnt(6)
v_mfma_f32_32x32x16_bf16 v[16:31], v[120:123], v[124:127], v[16:31]
ds_read_b128 v[120:123], v109 offset:160
ds_read_b128 v[124:127], v110 offset:160
s_waitcnt lgkmcnt(6)
v_mfma_f32_32x32x16_bf16 v[16:31], v[128:131], v[132:135], v[16:31]
ds_read_b128 v[128:131], v109 offset:192
ds_read_b128 v[132:135], v110 offset:192
s_waitcnt lgkmcnt(6)
v_mfma_f32_32x32x16_bf16 v[16:31], v[136:139], v[140:143], v[16:31]
ds_read_b128 v[136:139], v109 offset:224
ds_read_b128 v[140:143], v110 offset:224
s_waitcnt lgkmcnt(6)
v_mfma_f32_32x32x16_bf16 v[16:31], v[112:115], v[116:119], v[16:31]
ds_read_b128 v[112:115], v109 offset:256
ds_read_b128 v[116:119], v110 offset:256
s_waitcnt lgkmcnt(6)
v_mfma_f32_32x32x16_bf16 v[16:31], v[120:123], v[124:127], v[16:31]
ds_read_b128 v[120:123], v109 offset:288
ds_read_b128 v[124:127], v110 offset:288
s_waitcnt lgkmcnt(6)
v_mfma_f32_32x32x16_bf16 v[16:31], v[128:131], v[132:135], v[16:31]
ds_read_b128 v[128:131], v109 offset:320
ds_read_b128 v[132:135], v110 offset:320
s_waitcnt lgkmcnt(6)
v_mfma_f32_32x32x16_bf16 v[16:31], v[136:139], v[140:143], v[16:31]
ds_read_b128 v[136:139], v109 offset:352
ds_read_b128 v[140:143], v110 offset:352
s_waitcnt lgkmcnt(6)
v_mfma_f32_32x32x16_bf16 v[16:31], v[112:115], v[116:119], v[16:31]
ds_read_b128 v[112:115], v109 offset:384
ds_read_b128 v[116:119], v110 offset:384
s_waitcnt lgkmcnt(6)
v_mfma_f32_32x32x16_bf16 v[16:31], v[120:123], v[124:127], v[16:31]
ds_read_b128 v[120:123], v109 offset:416
ds_read_b128 v[124:127], v110 offset:416
s_waitcnt lgkmcnt(6)
v_mfma_f32_32x32x16_bf16 v[16:31], v[128:131], v[132:135], v[16:31]
ds_read_b128 v[128:131], v109 offset:448
ds_read_b128 v[132:135], v110 offset:448
s_waitcnt lgkmcnt(6)
v_mfma_f32_32x32x16_bf16 v[16:31], v[136:139], v[140:143], v[16:31]
ds_read_b128 v[136:139], v109 offset:480
ds_read_b128 v[140:143], v110 offset:480
s_waitcnt lgkmcnt(6)
v_mfma_f32_32x32x16_bf16 v[16:31], v[112:115], v[116:119], v[16:31]
s_waitcnt lgkmcnt(4)
v_mfma_f32_32x32x16_bf16 v[16:31], v[120:123], v[124:127], v[16:31]
s_waitcnt lgkmcnt(2)
v_mfma_f32_32x32x16_bf16 v[16:31], v[128:131], v[132:135], v[16:31]
s_waitcnt lgkmcnt(0)
v_mfma_f32_32x32x16_bf16 v[16:31], v[136:139], v[140:143], v[16:31]
s_add_u32 s90, s3, 4
s_mul_i32 s90, s90, 16896
v_lshlrev_b32 v111, 4, v0
v_add_u32 v111, s90, v111
s_xor_b32 s91, s3, 1
s_add_u32 s91, s91, 4
s_mul_i32 s91, s91, 16896
v_lshlrev_b32 v106, 4, v0
v_add_u32 v106, s91, v106
s_nop 7
s_nop 3
s_cmp_eq_u32 s86, 0
s_cbranch_scc0 LM_send1
ds_write_b128 v111, v[24:27]
ds_write_b128 v111, v[28:31] offset:1024
s_branch LM_sent
LM_send1:
ds_write_b128 v111, v[16:19]
ds_write_b128 v111, v[20:23] offset:1024
LM_sent:
v_mov_b32 v111, v106
s_waitcnt lgkmcnt(0)
s_barrier
ds_read_b128 v[32:35], v111
ds_read_b128 v[36:39], v111 offset:1024
v_and_b32 v41, 31, v0
v_lshrrev_b32 v42, 5, v0
s_mul_i32 s90, s85, 8320
s_cmp_eq_u32 s86, 0
s_cbranch_scc0 LM_exp1
v_lshlrev_b32 v40, 4, v41
v_lshlrev_b32 v3, 3, v42
v_add_u32 v40, v40, v3
v_sub_u32 v40, 4088, v40
v_add_u32 v40, s90, v40
s_waitcnt lgkmcnt(0)
v_add_f32 v16, v16, v32
v_add_f32 v17, v17, v33
v_add_f32 v18, v18, v34
v_add_f32 v19, v19, v35
v_add_f32 v20, v20, v36
v_add_f32 v21, v21, v37
v_add_f32 v22, v22, v38
v_add_f32 v23, v23, v39
v_cvt_pk_bf16_f32 v44, v19, v18
v_cvt_pk_bf16_f32 v45, v17, v16
v_cvt_pk_bf16_f32 v46, v20, v19
v_cvt_pk_bf16_f32 v47, v18, v17
ds_write_b64 v40, v[44:45] offset:4160
ds_write_b64 v40, v[46:47]
v_cvt_pk_bf16_f32 v48, v23, v22
v_cvt_pk_bf16_f32 v49, v21, v21
v_cvt_pk_bf16_f32 v50, v23, v23
v_cvt_pk_bf16_f32 v51, v22, v21
v_subrev_u32 v40, 512, v40
ds_write_b64 v40, v[48:49] offset:4160
ds_write_b64 v40, v[50:51]
v_mov_b32 v52, 0
v_cvt_pk_bf16_f32 v53, v16, v52
v_cmp_eq_u32 vcc, 0, v0
v_lshlrev_b32 v3, 2, v0
v_add_u32 v3, s90, v3
v_cndmask_b32 v53, v52, v53, vcc
s_mov_b64 exec, 0xff
ds_write_b32 v3, v53 offset:4096
ds_write_b32 v3, v52 offset:8256
s_mov_b64 exec, -1
s_branch LM_expd
LM_exp1:
v_lshlrev_b32 v40, 4, v41
v_lshlrev_b32 v3, 9, v42
v_add_u32 v40, v40, v3
v_sub_u32 v40, 3056, v40
v_add_u32 v40, s90, v40
v_lshlrev_b32 v43, 4, v41
v_lshlrev_b32 v3, 10, v42
v_add_u32 v43, v43, v3
v_sub_u32 v43, 1520, v43
v_add_u32 v43, s90, v43
v_and_b32 v3, 1, v41
v_cmp_eq_u32 vcc, 0, v3
s_waitcnt lgkmcnt(0)
v_add_f32 v24, v24, v32
v_add_f32 v25, v25, v33
v_add_f32 v26, v26, v34
v_add_f32 v27, v27, v35
v_add_f32 v28, v28, v36
v_add_f32 v29, v29, v37
v_add_f32 v30, v30, v38
v_add_f32 v31, v31, v39
v_cvt_pk_bf16_f32 v44, v26, v26
v_cvt_pk_bf16_f32 v45, v25, v25
v_cvt_pk_bf16_f32 v46, v25, v24
v_cvt_pk_bf16_f32 v47, v24, v24
ds_write_b128 v40, v[44:47] offset:4160
v_cvt_pk_bf16_f32 v48, v26, v26
v_cvt_pk_bf16_f32 v49, v26, v25
v_cvt_pk_bf16_f32 v50, v25, v25
v_cvt_pk_bf16_f32 v51, v24, v24
ds_write_b128 v40, v[48:51]
v_cndmask_b32 v60, v28, v27, vcc
v_cvt_pk_bf16_f32 v52, v28, v28
v_cvt_pk_bf16_f32 v53, v28, v60
v_cvt_pk_bf16_f32 v54, v27, v27
v_cvt_pk_bf16_f32 v55, v27, v27
ds_write_b128 v43, v[52:55] offset:4672
v_cvt_pk_bf16_f32 v56, v28, v28
v_cvt_pk_bf16_f32 v57, v28, v28
v_cvt_pk_bf16_f32 v58, v60, v27
v_cvt_pk_bf16_f32 v59, v27, v27
ds_write_b128 v43, v[56:59] offset:512
v_cndmask_b32 v60, v30, v29, vcc
v_cvt_pk_bf16_f32 v44, v30, v30
v_cvt_pk_bf16_f32 v45, v30, v60
v_cvt_pk_bf16_f32 v46, v29, v29
v_cvt_pk_bf16_f32 v47, v29, v29
ds_write_b128 v43, v[44:47] offset:4160
v_cvt_pk_bf16_f32 v48, v30, v30
v_cvt_pk_bf16_f32 v49, v30, v30
v_cvt_pk_bf16_f32 v50, v60, v29
v_cvt_pk_bf16_f32 v51, v29, v29
ds_write_b128 v43, v[48:51] offset:0
LM_expd:
s_waitcnt lgkmcnt(0)
s_barrier
s_setprio 1
ds_read2_b32 v[64:65], v208 offset0:224 offset1:225
ds_read2_b32 v[66:67], v208 offset0:226 offset1:227
ds_read_b128 v[192:195], v212 offset:3968
ds_read2_b32 v[68:69], v208 offset0:192 offset1:193
ds_read2_b32 v[70:71], v208 offset0:194 offset1:195
ds_read_b128 v[196:199], v212 offset:3840
ds_read2_b32 v[72:73], v208 offset0:160 offset1:161
ds_read2_b32 v[74:75], v208 offset0:162 offset1:163
ds_read_b128 v[200:203], v212 offset:3712
s_waitcnt lgkmcnt(6)
v_mfma_f32_16x16x32_bf16 v[60:63], v[64:67], v[192:195], 0
ds_read2_b32 v[76:77], v208 offset0:128 offset1:129
ds_read2_b32 v[78:79], v208 offset0:130 offset1:131
ds_read_b128 v[204:207], v212 offset:3584
s_waitcnt lgkmcnt(6)
v_mfma_f32_16x16x32_bf16 v[60:63], v[68:71], v[196:199], v[60:63]
ds_read2_b32 v[80:81], v208 offset0:96 offset1:97
ds_read2_b32 v[82:83], v208 offset0:98 offset1:99
ds_read_b128 v[192:195], v212 offset:3456
s_waitcnt lgkmcnt(6)
v_mfma_f32_16x16x32_bf16 v[60:63], v[72:75], v[200:203], v[60:63]
ds_read2_b32 v[84:85], v208 offset0:64 offset1:65
ds_read2_b32 v[86:87], v208 offset0:66 offset1:67
ds_read_b128 v[196:199], v212 offset:3328
s_waitcnt lgkmcnt(6)
v_mfma_f32_16x16x32_bf16 v[60:63], v[76:79], v[204:207], v[60:63]
ds_read2_b32 v[88:89], v208 offset0:32 offset1:33
ds_read2_b32 v[90:91], v208 offset0:34 offset1:35
ds_read_b128 v[200:203], v212 offset:3200
s_waitcnt lgkmcnt(6)
v_mfma_f32_16x16x32_bf16 v[60:63], v[80:83], v[192:195], v[60:63]
ds_read2_b32 v[92:93], v208 offset0:0 offset1:1
v_mfma_f32_16x16x32_bf16 v[56:59], v[64:67], v[192:195], 0
ds_read2_b32 v[94:95], v208 offset0:2 offset1:3
ds_read_b128 v[204:207], v212 offset:3072
s_waitcnt lgkmcnt(6)
v_mfma_f32_16x16x32_bf16 v[60:63], v[84:87], v[196:199], v[60:63]
ds_read2_b32 v[96:97], v209 offset0:224 offset1:225
v_mfma_f32_16x16x32_bf16 v[56:59], v[68:71], v[196:199], v[56:59]
ds_read2_b32 v[98:99], v209 offset0:226 offset1:227
ds_read_b128 v[192:195], v212 offset:2944
s_waitcnt lgkmcnt(6)
v_mfma_f32_16x16x32_bf16 v[60:63], v[88:91], v[200:203], v[60:63]
ds_read2_b32 v[100:101], v209 offset0:192 offset1:193
v_mfma_f32_16x16x32_bf16 v[56:59], v[72:75], v[200:203], v[56:59]
ds_read2_b32 v[102:103], v209 offset0:194 offset1:195
ds_read_b128 v[196:199], v212 offset:2816
s_waitcnt lgkmcnt(6)
v_mfma_f32_16x16x32_bf16 v[60:63], v[92:95], v[204:207], v[60:63]
ds_read2_b32 v[104:105], v209 offset0:160 offset1:161
v_mfma_f32_16x16x32_bf16 v[56:59], v[76:79], v[204:207], v[56:59]
ds_read2_b32 v[106:107], v209 offset0:162 offset1:163
ds_read_b128 v[200:203], v212 offset:2688
s_waitcnt lgkmcnt(6)
v_mfma_f32_16x16x32_bf16 v[60:63], v[96:99], v[192:195], v[60:63]
ds_read2_b32 v[108:109], v209 offset0:128 offset1:129
v_mfma_f32_16x16x32_bf16 v[56:59], v[80:83], v[192:195], v[56:59]
ds_read2_b32 v[110:111], v209 offset0:130 offset1:131
v_mfma_f32_16x16x32_bf16 v[52:55], v[64:67], v[192:195], 0
ds_read_b128 v[204:207], v212 offset:2560
s_waitcnt lgkmcnt(6)
v_mfma_f32_16x16x32_bf16 v[60:63], v[100:103], v[196:199], v[60:63]
ds_read2_b32 v[112:113], v209 offset0:96 offset1:97
v_mfma_f32_16x16x32_bf16 v[56:59], v[84:87], v[196:199], v[56:59]
ds_read2_b32 v[114:115], v209 offset0:98 offset1:99
v_mfma_f32_16x16x32_bf16 v[52:55], v[68:71], v[196:199], v[52:55]
ds_read_b128 v[192:195], v212 offset:2432
s_waitcnt lgkmcnt(6)
v_mfma_f32_16x16x32_bf16 v[60:63], v[104:107], v[200:203], v[60:63]
ds_read2_b32 v[116:117], v209 offset0:64 offset1:65
v_mfma_f32_16x16x32_bf16 v[56:59], v[88:91], v[200:203], v[56:59]
ds_read2_b32 v[118:119], v209 offset0:66 offset1:67
v_mfma_f32_16x16x32_bf16 v[52:55], v[72:75], v[200:203], v[52:55]
ds_read_b128 v[196:199], v212 offset:2304
s_waitcnt lgkmcnt(6)
v_mfma_f32_16x16x32_bf16 v[60:63], v[108:111], v[204:207], v[60:63]
ds_read2_b32 v[120:121], v209 offset0:32 offset1:33
v_mfma_f32_16x16x32_bf16 v[56:59], v[92:95], v[204:207], v[56:59]
ds_read2_b32 v[122:123], v209 offset0:34 offset1:35
v_mfma_f32_16x16x32_bf16 v[52:55], v[76:79], v[204:207], v[52:55]
ds_read_b128 v[200:203], v212 offset:2176
s_waitcnt lgkmcnt(6)
v_mfma_f32_16x16x32_bf16 v[60:63], v[112:115], v[192:195], v[60:63]
ds_read2_b32 v[124:125], v209 offset0:0 offset1:1
v_mfma_f32_16x16x32_bf16 v[56:59], v[96:99], v[192:195], v[56:59]
ds_read2_b32 v[126:127], v209 offset0:2 offset1:3
v_mfma_f32_16x16x32_bf16 v[52:55], v[80:83], v[192:195], v[52:55]
ds_read_b128 v[204:207], v212 offset:2048
v_mfma_f32_16x16x32_bf16 v[48:51], v[64:67], v[192:195], 0
s_waitcnt lgkmcnt(6)
v_mfma_f32_16x16x32_bf16 v[60:63], v[116:119], v[196:199], v[60:63]
ds_read2_b32 v[128:129], v210 offset0:224 offset1:225
v_mfma_f32_16x16x32_bf16 v[56:59], v[100:103], v[196:199], v[56:59]
ds_read2_b32 v[130:131], v210 offset0:226 offset1:227
v_mfma_f32_16x16x32_bf16 v[52:55], v[84:87], v[196:199], v[52:55]
ds_read_b128 v[192:195], v212 offset:1920
v_mfma_f32_16x16x32_bf16 v[48:51], v[68:71], v[196:199], v[48:51]
s_waitcnt lgkmcnt(6)
v_mfma_f32_16x16x32_bf16 v[60:63], v[120:123], v[200:203], v[60:63]
ds_read2_b32 v[132:133], v210 offset0:192 offset1:193
v_mfma_f32_16x16x32_bf16 v[56:59], v[104:107], v[200:203], v[56:59]
ds_read2_b32 v[134:135], v210 offset0:194 offset1:195
v_mfma_f32_16x16x32_bf16 v[52:55], v[88:91], v[200:203], v[52:55]
ds_read_b128 v[196:199], v212 offset:1792
v_mfma_f32_16x16x32_bf16 v[48:51], v[72:75], v[200:203], v[48:51]
s_waitcnt lgkmcnt(6)
v_mfma_f32_16x16x32_bf16 v[60:63], v[124:127], v[204:207], v[60:63]
ds_read2_b32 v[136:137], v210 offset0:160 offset1:161
v_mfma_f32_16x16x32_bf16 v[56:59], v[108:111], v[204:207], v[56:59]
ds_read2_b32 v[138:139], v210 offset0:162 offset1:163
v_mfma_f32_16x16x32_bf16 v[52:55], v[92:95], v[204:207], v[52:55]
ds_read_b128 v[200:203], v212 offset:1664
v_mfma_f32_16x16x32_bf16 v[48:51], v[76:79], v[204:207], v[48:51]
s_waitcnt lgkmcnt(6)
v_mfma_f32_16x16x32_bf16 v[60:63], v[128:131], v[192:195], v[60:63]
ds_read2_b32 v[140:141], v210 offset0:128 offset1:129
v_mfma_f32_16x16x32_bf16 v[56:59], v[112:115], v[192:195], v[56:59]
ds_read2_b32 v[142:143], v210 offset0:130 offset1:131
v_mfma_f32_16x16x32_bf16 v[52:55], v[96:99], v[192:195], v[52:55]
ds_read_b128 v[204:207], v212 offset:1536
v_mfma_f32_16x16x32_bf16 v[48:51], v[80:83], v[192:195], v[48:51]
v_mfma_f32_16x16x32_bf16 v[44:47], v[64:67], v[192:195], 0
s_waitcnt lgkmcnt(6)
v_mfma_f32_16x16x32_bf16 v[60:63], v[132:135], v[196:199], v[60:63]
ds_read2_b32 v[144:145], v210 offset0:96 offset1:97
v_mfma_f32_16x16x32_bf16 v[56:59], v[116:119], v[196:199], v[56:59]
ds_read2_b32 v[146:147], v210 offset0:98 offset1:99
v_mfma_f32_16x16x32_bf16 v[52:55], v[100:103], v[196:199], v[52:55]
ds_read_b128 v[192:195], v212 offset:1408
v_mfma_f32_16x16x32_bf16 v[48:51], v[84:87], v[196:199], v[48:51]
v_mfma_f32_16x16x32_bf16 v[44:47], v[68:71], v[196:199], v[44:47]
s_waitcnt lgkmcnt(6)
v_mfma_f32_16x16x32_bf16 v[60:63], v[136:139], v[200:203], v[60:63]
ds_read2_b32 v[148:149], v210 offset0:64 offset1:65
v_mfma_f32_16x16x32_bf16 v[56:59], v[120:123], v[200:203], v[56:59]
ds_read2_b32 v[150:151], v210 offset0:66 offset1:67
v_mfma_f32_16x16x32_bf16 v[52:55], v[104:107], v[200:203], v[52:55]
ds_read_b128 v[196:199], v212 offset:1280
v_mfma_f32_16x16x32_bf16 v[48:51], v[88:91], v[200:203], v[48:51]
v_mfma_f32_16x16x32_bf16 v[44:47], v[72:75], v[200:203], v[44:47]
s_waitcnt lgkmcnt(6)
v_mfma_f32_16x16x32_bf16 v[60:63], v[140:143], v[204:207], v[60:63]
ds_read2_b32 v[152:153], v210 offset0:32 offset1:33
v_mfma_f32_16x16x32_bf16 v[56:59], v[124:127], v[204:207], v[56:59]
ds_read2_b32 v[154:155], v210 offset0:34 offset1:35
v_mfma_f32_16x16x32_bf16 v[52:55], v[108:111], v[204:207], v[52:55]
ds_read_b128 v[200:203], v212 offset:1152
v_mfma_f32_16x16x32_bf16 v[48:51], v[92:95], v[204:207], v[48:51]
v_mfma_f32_16x16x32_bf16 v[44:47], v[76:79], v[204:207], v[44:47]
s_waitcnt lgkmcnt(6)
v_mfma_f32_16x16x32_bf16 v[60:63], v[144:147], v[192:195], v[60:63]
ds_read2_b32 v[156:157], v210 offset0:0 offset1:1
v_mfma_f32_16x16x32_bf16 v[56:59], v[128:131], v[192:195], v[56:59]
ds_read2_b32 v[158:159], v210 offset0:2 offset1:3
v_mfma_f32_16x16x32_bf16 v[52:55], v[112:115], v[192:195], v[52:55]
ds_read_b128 v[204:207], v212 offset:1024
v_mfma_f32_16x16x32_bf16 v[48:51], v[96:99], v[192:195], v[48:51]
v_mfma_f32_16x16x32_bf16 v[44:47], v[80:83], v[192:195], v[44:47]
v_mfma_f32_16x16x32_bf16 v[40:43], v[64:67], v[192:195], 0
s_waitcnt lgkmcnt(6)
v_mfma_f32_16x16x32_bf16 v[60:63], v[148:151], v[196:199], v[60:63]
ds_read2_b32 v[160:161], v211 offset0:224 offset1:225
v_mfma_f32_16x16x32_bf16 v[56:59], v[132:135], v[196:199], v[56:59]
ds_read2_b32 v[162:163], v211 offset0:226 offset1:227
v_mfma_f32_16x16x32_bf16 v[52:55], v[116:119], v[196:199], v[52:55]
ds_read_b128 v[192:195], v212 offset:896
v_mfma_f32_16x16x32_bf16 v[48:51], v[100:103], v[196:199], v[48:51]
v_mfma_f32_16x16x32_bf16 v[44:47], v[84:87], v[196:199], v[44:47]
v_mfma_f32_16x16x32_bf16 v[40:43], v[68:71], v[196:199], v[40:43]
s_waitcnt lgkmcnt(6)
v_mfma_f32_16x16x32_bf16 v[60:63], v[152:155], v[200:203], v[60:63]
ds_read2_b32 v[164:165], v211 offset0:192 offset1:193
v_mfma_f32_16x16x32_bf16 v[56:59], v[136:139], v[200:203], v[56:59]
ds_read2_b32 v[166:167], v211 offset0:194 offset1:195
v_mfma_f32_16x16x32_bf16 v[52:55], v[120:123], v[200:203], v[52:55]
ds_read_b128 v[196:199], v212 offset:768
v_mfma_f32_16x16x32_bf16 v[48:51], v[104:107], v[200:203], v[48:51]
v_mfma_f32_16x16x32_bf16 v[44:47], v[88:91], v[200:203], v[44:47]
v_mfma_f32_16x16x32_bf16 v[40:43], v[72:75], v[200:203], v[40:43]
s_waitcnt lgkmcnt(6)
v_mfma_f32_16x16x32_bf16 v[60:63], v[156:159], v[204:207], v[60:63]
ds_read2_b32 v[168:169], v211 offset0:160 offset1:161
v_mfma_f32_16x16x32_bf16 v[56:59], v[140:143], v[204:207], v[56:59]
ds_read2_b32 v[170:171], v211 offset0:162 offset1:163
v_mfma_f32_16x16x32_bf16 v[52:55], v[124:127], v[204:207], v[52:55]
ds_read_b128 v[200:203], v212 offset:640
v_mfma_f32_16x16x32_bf16 v[48:51], v[108:111], v[204:207], v[48:51]
v_mfma_f32_16x16x32_bf16 v[44:47], v[92:95], v[204:207], v[44:47]
v_mfma_f32_16x16x32_bf16 v[40:43], v[76:79], v[204:207], v[40:43]
s_waitcnt lgkmcnt(6)
v_mfma_f32_16x16x32_bf16 v[60:63], v[160:163], v[192:195], v[60:63]
ds_read2_b32 v[172:173], v211 offset0:128 offset1:129
v_mfma_f32_16x16x32_bf16 v[56:59], v[144:147], v[192:195], v[56:59]
ds_read2_b32 v[174:175], v211 offset0:130 offset1:131
v_mfma_f32_16x16x32_bf16 v[52:55], v[128:131], v[192:195], v[52:55]
ds_read_b128 v[204:207], v212 offset:512
v_mfma_f32_16x16x32_bf16 v[48:51], v[112:115], v[192:195], v[48:51]
v_mfma_f32_16x16x32_bf16 v[44:47], v[96:99], v[192:195], v[44:47]
v_mfma_f32_16x16x32_bf16 v[40:43], v[80:83], v[192:195], v[40:43]
v_mfma_f32_16x16x32_bf16 v[36:39], v[64:67], v[192:195], 0
s_waitcnt lgkmcnt(6)
v_mfma_f32_16x16x32_bf16 v[60:63], v[164:167], v[196:199], v[60:63]
ds_read2_b32 v[176:177], v211 offset0:96 offset1:97
v_mfma_f32_16x16x32_bf16 v[56:59], v[148:151], v[196:199], v[56:59]
ds_read2_b32 v[178:179], v211 offset0:98 offset1:99
v_mfma_f32_16x16x32_bf16 v[52:55], v[132:135], v[196:199], v[52:55]
ds_read_b128 v[192:195], v212 offset:384
v_mfma_f32_16x16x32_bf16 v[48:51], v[116:119], v[196:199], v[48:51]
v_mfma_f32_16x16x32_bf16 v[44:47], v[100:103], v[196:199], v[44:47]
v_mfma_f32_16x16x32_bf16 v[40:43], v[84:87], v[196:199], v[40:43]
v_mfma_f32_16x16x32_bf16 v[36:39], v[68:71], v[196:199], v[36:39]
s_waitcnt lgkmcnt(6)
v_mfma_f32_16x16x32_bf16 v[60:63], v[168:171], v[200:203], v[60:63]
ds_read2_b32 v[180:181], v211 offset0:64 offset1:65
v_mfma_f32_16x16x32_bf16 v[56:59], v[152:155], v[200:203], v[56:59]
ds_read2_b32 v[182:183], v211 offset0:66 offset1:67
v_mfma_f32_16x16x32_bf16 v[52:55], v[136:139], v[200:203], v[52:55]
ds_read_b128 v[196:199], v212 offset:256
v_mfma_f32_16x16x32_bf16 v[48:51], v[120:123], v[200:203], v[48:51]
v_mfma_f32_16x16x32_bf16 v[44:47], v[104:107], v[200:203], v[44:47]
v_mfma_f32_16x16x32_bf16 v[40:43], v[88:91], v[200:203], v[40:43]
v_mfma_f32_16x16x32_bf16 v[36:39], v[72:75], v[200:203], v[36:39]
s_waitcnt lgkmcnt(6)
v_mfma_f32_16x16x32_bf16 v[60:63], v[172:175], v[204:207], v[60:63]
ds_read2_b32 v[184:185], v211 offset0:32 offset1:33
v_mfma_f32_16x16x32_bf16 v[56:59], v[156:159], v[204:207], v[56:59]
ds_read2_b32 v[186:187], v211 offset0:34 offset1:35
v_mfma_f32_16x16x32_bf16 v[52:55], v[140:143], v[204:207], v[52:55]
ds_read_b128 v[200:203], v212 offset:128
v_mfma_f32_16x16x32_bf16 v[48:51], v[124:127], v[204:207], v[48:51]
v_mfma_f32_16x16x32_bf16 v[44:47], v[108:111], v[204:207], v[44:47]
v_mfma_f32_16x16x32_bf16 v[40:43], v[92:95], v[204:207], v[40:43]
v_mfma_f32_16x16x32_bf16 v[36:39], v[76:79], v[204:207], v[36:39]
s_waitcnt lgkmcnt(6)
v_mfma_f32_16x16x32_bf16 v[60:63], v[176:179], v[192:195], v[60:63]
ds_read2_b32 v[188:189], v211 offset0:0 offset1:1
v_mfma_f32_16x16x32_bf16 v[56:59], v[160:163], v[192:195], v[56:59]
ds_read2_b32 v[190:191], v211 offset0:2 offset1:3
v_mfma_f32_16x16x32_bf16 v[52:55], v[144:147], v[192:195], v[52:55]
ds_read_b128 v[204:207], v212 offset:0
v_mfma_f32_16x16x32_bf16 v[48:51], v[128:131], v[192:195], v[48:51]
v_mfma_f32_16x16x32_bf16 v[44:47], v[112:115], v[192:195], v[44:47]
v_mfma_f32_16x16x32_bf16 v[40:43], v[96:99], v[192:195], v[40:43]
v_mfma_f32_16x16x32_bf16 v[36:39], v[80:83], v[192:195], v[36:39]
v_mfma_f32_16x16x32_bf16 v[32:35], v[64:67], v[192:195], 0
s_waitcnt lgkmcnt(6)
v_mfma_f32_16x16x32_bf16 v[60:63], v[180:183], v[196:199], v[60:63]
v_mfma_f32_16x16x32_bf16 v[56:59], v[164:167], v[196:199], v[56:59]
v_mfma_f32_16x16x32_bf16 v[52:55], v[148:151], v[196:199], v[52:55]
v_mfma_f32_16x16x32_bf16 v[48:51], v[132:135], v[196:199], v[48:51]
v_mfma_f32_16x16x32_bf16 v[44:47], v[116:119], v[196:199], v[44:47]
v_mfma_f32_16x16x32_bf16 v[40:43], v[100:103], v[196:199], v[40:43]
v_mfma_f32_16x16x32_bf16 v[36:39], v[84:87], v[196:199], v[36:39]
v_mfma_f32_16x16x32_bf16 v[32:35], v[68:71], v[196:199], v[32:35]
s_waitcnt lgkmcnt(3)
v_mfma_f32_16x16x32_bf16 v[60:63], v[184:187], v[200:203], v[60:63]
v_mfma_f32_16x16x32_bf16 v[56:59], v[168:171], v[200:203], v[56:59]
v_mfma_f32_16x16x32_bf16 v[52:55], v[152:155], v[200:203], v[52:55]
v_mfma_f32_16x16x32_bf16 v[48:51], v[136:139], v[200:203], v[48:51]
v_mfma_f32_16x16x32_bf16 v[44:47], v[120:123], v[200:203], v[44:47]
v_mfma_f32_16x16x32_bf16 v[40:43], v[104:107], v[200:203], v[40:43]
v_mfma_f32_16x16x32_bf16 v[36:39], v[88:91], v[200:203], v[36:39]
v_mfma_f32_16x16x32_bf16 v[32:35], v[72:75], v[200:203], v[32:35]
s_waitcnt lgkmcnt(0)
v_mfma_f32_16x16x32_bf16 v[60:63], v[188:191], v[204:207], v[60:63]
v_mfma_f32_16x16x32_bf16 v[56:59], v[172:175], v[204:207], v[56:59]
v_mfma_f32_16x16x32_bf16 v[52:55], v[156:159], v[204:207], v[52:55]
v_mfma_f32_16x16x32_bf16 v[48:51], v[140:143], v[204:207], v[48:51]
v_mfma_f32_16x16x32_bf16 v[44:47], v[124:127], v[204:207], v[44:47]
v_mfma_f32_16x16x32_bf16 v[40:43], v[108:111], v[204:207], v[40:43]
v_mfma_f32_16x16x32_bf16 v[36:39], v[92:95], v[204:207], v[36:39]
v_mfma_f32_16x16x32_bf16 v[32:35], v[76:79], v[204:207], v[32:35]
v_mov_b32 v222, s67
ds_read_b64 v[64:65], v216 offset:0
ds_read_b64 v[66:67], v216 offset:512
ds_read_b64 v[68:69], v216 offset:1024
ds_read_b64 v[70:71], v216 offset:1536
s_nop 3
s_cmp_eq_u32 s86, 0
s_cbranch_scc0 LM_cx1
ds_write_b128 v215, v[48:51] offset:0
ds_write_b128 v215, v[52:55] offset:1024
ds_write_b128 v215, v[56:59] offset:2048
ds_write_b128 v215, v[60:63] offset:3072
s_waitcnt lgkmcnt(0)
s_barrier
ds_read_b64 v[72:73], v217 offset:0
ds_read_b64 v[74:75], v217 offset:512
ds_read_b64 v[76:77], v217 offset:1024
ds_read_b64 v[78:79], v217 offset:1536
ds_read_b128 v[80:83], v220 offset:0
ds_read_b128 v[84:87], v220 offset:1024
ds_read_b128 v[88:91], v220 offset:2048
ds_read_b128 v[92:95], v220 offset:3072
v_lshlrev_b32 v96, 16, v64
v_and_b32 v97, 0xffff0000, v64
v_lshlrev_b32 v98, 16, v65
v_and_b32 v99, 0xffff0000, v65
v_pk_fma_f32 v[32:33], v[96:97], v[222:223], v[32:33] op_sel_hi:[1,0,1]
v_pk_fma_f32 v[34:35], v[98:99], v[222:223], v[34:35] op_sel_hi:[1,0,1]
v_lshlrev_b32 v96, 16, v66
v_and_b32 v97, 0xffff0000, v66
v_lshlrev_b32 v98, 16, v67
v_and_b32 v99, 0xffff0000, v67
v_pk_fma_f32 v[36:37], v[96:97], v[222:223], v[36:37] op_sel_hi:[1,0,1]
v_pk_fma_f32 v[38:39], v[98:99], v[222:223], v[38:39] op_sel_hi:[1,0,1]
v_lshlrev_b32 v96, 16, v68
v_and_b32 v97, 0xffff0000, v68
v_lshlrev_b32 v98, 16, v69
v_and_b32 v99, 0xffff0000, v69
v_pk_fma_f32 v[40:41], v[96:97], v[222:223], v[40:41] op_sel_hi:[1,0,1]
v_pk_fma_f32 v[42:43], v[98:99], v[222:223], v[42:43] op_sel_hi:[1,0,1]
v_lshlrev_b32 v96, 16, v70
v_and_b32 v97, 0xffff0000, v70
v_lshlrev_b32 v98, 16, v71
v_and_b32 v99, 0xffff0000, v71
v_pk_fma_f32 v[44:45], v[96:97], v[222:223], v[44:45] op_sel_hi:[1,0,1]
v_pk_fma_f32 v[46:47], v[98:99], v[222:223], v[46:47] op_sel_hi:[1,0,1]
s_waitcnt lgkmcnt(3)
v_lshlrev_b32 v100, 16, v72
v_and_b32 v101, 0xffff0000, v72
v_lshlrev_b32 v102, 16, v73
v_and_b32 v103, 0xffff0000, v73
v_pk_add_f32 v[32:33], v[32:33], v[80:81]
v_pk_add_f32 v[34:35], v[34:35], v[82:83]
v_pk_add_f32 v[32:33], v[32:33], v[100:101]
v_pk_add_f32 v[34:35], v[34:35], v[102:103]
v_cvt_pk_bf16_f32 v104, v32, v33
v_cvt_pk_bf16_f32 v105, v34, v35
buffer_store_dwordx2 v[104:105], v219, s[40:43], s66 offen
s_add_u32 s66, s66, 229376
s_waitcnt lgkmcnt(2)
v_lshlrev_b32 v100, 16, v74
v_and_b32 v101, 0xffff0000, v74
v_lshlrev_b32 v102, 16, v75
v_and_b32 v103, 0xffff0000, v75
v_pk_add_f32 v[36:37], v[36:37], v[84:85]
v_pk_add_f32 v[38:39], v[38:39], v[86:87]
v_pk_add_f32 v[36:37], v[36:37], v[100:101]
v_pk_add_f32 v[38:39], v[38:39], v[102:103]
v_cvt_pk_bf16_f32 v106, v36, v37
v_cvt_pk_bf16_f32 v107, v38, v39
buffer_store_dwordx2 v[106:107], v219, s[40:43], s66 offen
s_add_u32 s66, s66, 229376
s_waitcnt lgkmcnt(1)
v_lshlrev_b32 v100, 16, v76
v_and_b32 v101, 0xffff0000, v76
v_lshlrev_b32 v102, 16, v77
v_and_b32 v103, 0xffff0000, v77
v_pk_add_f32 v[40:41], v[40:41], v[88:89]
v_pk_add_f32 v[42:43], v[42:43], v[90:91]
v_pk_add_f32 v[40:41], v[40:41], v[100:101]
v_pk_add_f32 v[42:43], v[42:43], v[102:103]
v_cvt_pk_bf16_f32 v108, v40, v41
v_cvt_pk_bf16_f32 v109, v42, v43
buffer_store_dwordx2 v[108:109], v219, s[40:43], s66 offen
s_add_u32 s66, s66, 229376
s_waitcnt lgkmcnt(0)
v_lshlrev_b32 v100, 16, v78
v_and_b32 v101, 0xffff0000, v78
v_lshlrev_b32 v102, 16, v79
v_and_b32 v103, 0xffff0000, v79
v_pk_add_f32 v[44:45], v[44:45], v[92:93]
v_pk_add_f32 v[46:47], v[46:47], v[94:95]
v_pk_add_f32 v[44:45], v[44:45], v[100:101]
v_pk_add_f32 v[46:47], v[46:47], v[102:103]
v_cvt_pk_bf16_f32 v110, v44, v45
v_cvt_pk_bf16_f32 v111, v46, v47
buffer_store_dwordx2 v[110:111], v219, s[40:43], s66 offen
s_endpgm
LM_cx1:
ds_write_b128 v215, v[32:35] offset:0
ds_write_b128 v215, v[36:39] offset:1024
ds_write_b128 v215, v[40:43] offset:2048
ds_write_b128 v215, v[44:47] offset:3072
s_waitcnt lgkmcnt(0)
s_barrier
ds_read_b64 v[72:73], v217 offset:0
ds_read_b64 v[74:75], v217 offset:512
ds_read_b64 v[76:77], v217 offset:1024
ds_read_b64 v[78:79], v217 offset:1536
ds_read_b128 v[80:83], v220 offset:0
ds_read_b128 v[84:87], v220 offset:1024
ds_read_b128 v[88:91], v220 offset:2048
ds_read_b128 v[92:95], v220 offset:3072
v_lshlrev_b32 v96, 16, v64
v_and_b32 v97, 0xffff0000, v64
v_lshlrev_b32 v98, 16, v65
v_and_b32 v99, 0xffff0000, v65
v_pk_fma_f32 v[48:49], v[96:97], v[222:223], v[48:49] op_sel_hi:[1,0,1]
v_pk_fma_f32 v[50:51], v[98:99], v[222:223], v[50:51] op_sel_hi:[1,0,1]
v_lshlrev_b32 v96, 16, v66
v_and_b32 v97, 0xffff0000, v66
v_lshlrev_b32 v98, 16, v67
v_and_b32 v99, 0xffff0000, v67
v_pk_fma_f32 v[52:53], v[96:97], v[222:223], v[52:53] op_sel_hi:[1,0,1]
v_pk_fma_f32 v[54:55], v[98:99], v[222:223], v[54:55] op_sel_hi:[1,0,1]
v_lshlrev_b32 v96, 16, v68
v_and_b32 v97, 0xffff0000, v68
v_lshlrev_b32 v98, 16, v69
v_and_b32 v99, 0xffff0000, v69
v_pk_fma_f32 v[56:57], v[96:97], v[222:223], v[56:57] op_sel_hi:[1,0,1]
v_pk_fma_f32 v[58:59], v[98:99], v[222:223], v[58:59] op_sel_hi:[1,0,1]
v_lshlrev_b32 v96, 16, v70
v_and_b32 v97, 0xffff0000, v70
v_lshlrev_b32 v98, 16, v71
v_and_b32 v99, 0xffff0000, v71
v_pk_fma_f32 v[60:61], v[96:97], v[222:223], v[60:61] op_sel_hi:[1,0,1]
v_pk_fma_f32 v[62:63], v[98:99], v[222:223], v[62:63] op_sel_hi:[1,0,1]
s_waitcnt lgkmcnt(3)
v_lshlrev_b32 v100, 16, v72
v_and_b32 v101, 0xffff0000, v72
v_lshlrev_b32 v102, 16, v73
v_and_b32 v103, 0xffff0000, v73
v_pk_add_f32 v[48:49], v[48:49], v[80:81]
v_pk_add_f32 v[50:51], v[50:51], v[82:83]
v_pk_add_f32 v[48:49], v[48:49], v[100:101]
v_pk_add_f32 v[50:51], v[50:51], v[102:103]
v_cvt_pk_bf16_f32 v104, v48, v49
v_cvt_pk_bf16_f32 v105, v50, v51
buffer_store_dwordx2 v[104:105], v219, s[40:43], s66 offen
s_add_u32 s66, s66, 229376
s_waitcnt lgkmcnt(2)
v_lshlrev_b32 v100, 16, v74
v_and_b32 v101, 0xffff0000, v74
v_lshlrev_b32 v102, 16, v75
v_and_b32 v103, 0xffff0000, v75
v_pk_add_f32 v[52:53], v[52:53], v[84:85]
v_pk_add_f32 v[54:55], v[54:55], v[86:87]
v_pk_add_f32 v[52:53], v[52:53], v[100:101]
v_pk_add_f32 v[54:55], v[54:55], v[102:103]
v_cvt_pk_bf16_f32 v106, v52, v53
v_cvt_pk_bf16_f32 v107, v54, v55
buffer_store_dwordx2 v[106:107], v219, s[40:43], s66 offen
s_add_u32 s66, s66, 229376
s_waitcnt lgkmcnt(1)
v_lshlrev_b32 v100, 16, v76
v_and_b32 v101, 0xffff0000, v76
v_lshlrev_b32 v102, 16, v77
v_and_b32 v103, 0xffff0000, v77
v_pk_add_f32 v[56:57], v[56:57], v[88:89]
v_pk_add_f32 v[58:59], v[58:59], v[90:91]
v_pk_add_f32 v[56:57], v[56:57], v[100:101]
v_pk_add_f32 v[58:59], v[58:59], v[102:103]
v_cvt_pk_bf16_f32 v108, v56, v57
v_cvt_pk_bf16_f32 v109, v58, v59
buffer_store_dwordx2 v[108:109], v219, s[40:43], s66 offen
s_add_u32 s66, s66, 229376
s_waitcnt lgkmcnt(0)
v_lshlrev_b32 v100, 16, v78
v_and_b32 v101, 0xffff0000, v78
v_lshlrev_b32 v102, 16, v79
v_and_b32 v103, 0xffff0000, v79
v_pk_add_f32 v[60:61], v[60:61], v[92:93]
v_pk_add_f32 v[62:63], v[62:63], v[94:95]
v_pk_add_f32 v[60:61], v[60:61], v[100:101]
v_pk_add_f32 v[62:63], v[62:63], v[102:103]
v_cvt_pk_bf16_f32 v110, v60, v61
v_cvt_pk_bf16_f32 v111, v62, v63
buffer_store_dwordx2 v[110:111], v219, s[40:43], s66 offen
s_endpgm
LA_nwave:
s_waitcnt vmcnt(3)
s_mov_b32 s89, 0x9E3779B1
v_mul_lo_u32 v1, v2, s89
v_add_u32 v1, 0x7F4A7C15, v1
v_mov_b32 v12, 0
v_mov_b32 v13, 0
v_mov_b32 v180, 0
v_mov_b32 v181, 0
v_mov_b32 v4, 0x3f803f80
v_dot2c_f32_bf16 v12, v8, v4
v_dot2c_f32_bf16 v13, v8, v8
v_dot2c_f32_bf16 v180, v168, v4
v_dot2c_f32_bf16 v181, v168, v168
v_dot2c_f32_bf16 v12, v9, v4
v_dot2c_f32_bf16 v13, v9, v9
v_dot2c_f32_bf16 v180, v169, v4
v_dot2c_f32_bf16 v181, v169, v169
v_dot2c_f32_bf16 v12, v10, v4
v_dot2c_f32_bf16 v13, v10, v10
v_dot2c_f32_bf16 v180, v170, v4
v_dot2c_f32_bf16 v181, v170, v170
v_dot2c_f32_bf16 v12, v11, v4
v_dot2c_f32_bf16 v13, v11, v11
v_dot2c_f32_bf16 v180, v171, v4
v_dot2c_f32_bf16 v181, v171, v171
s_nop 2
v_add_f32_dpp v12, v12, v12 row_shr:1 row_mask:0xf bank_mask:0xf bound_ctrl:0
v_add_f32_dpp v13, v13, v13 row_shr:1 row_mask:0xf bank_mask:0xf bound_ctrl:0
v_add_f32_dpp v180, v180, v180 row_shr:1 row_mask:0xf bank_mask:0xf bound_ctrl:0
v_add_f32_dpp v181, v181, v181 row_shr:1 row_mask:0xf bank_mask:0xf bound_ctrl:0
v_add_f32_dpp v12, v12, v12 row_shr:2 row_mask:0xf bank_mask:0xf bound_ctrl:0
v_add_f32_dpp v13, v13, v13 row_shr:2 row_mask:0xf bank_mask:0xf bound_ctrl:0
v_add_f32_dpp v180, v180, v180 row_shr:2 row_mask:0xf bank_mask:0xf bound_ctrl:0
v_add_f32_dpp v181, v181, v181 row_shr:2 row_mask:0xf bank_mask:0xf bound_ctrl:0
v_add_f32_dpp v12, v12, v12 row_shr:4 row_mask:0xf bank_mask:0xf bound_ctrl:0
v_add_f32_dpp v13, v13, v13 row_shr:4 row_mask:0xf bank_mask:0xf bound_ctrl:0
v_add_f32_dpp v180, v180, v180 row_shr:4 row_mask:0xf bank_mask:0xf bound_ctrl:0
v_add_f32_dpp v181, v181, v181 row_shr:4 row_mask:0xf bank_mask:0xf bound_ctrl:0
v_add_f32_dpp v12, v12, v12 row_shr:8 row_mask:0xf bank_mask:0xf bound_ctrl:0
v_add_f32_dpp v13, v13, v13 row_shr:8 row_mask:0xf bank_mask:0xf bound_ctrl:0
v_add_f32_dpp v180, v180, v180 row_shr:8 row_mask:0xf bank_mask:0xf bound_ctrl:0
v_add_f32_dpp v181, v181, v181 row_shr:8 row_mask:0xf bank_mask:0xf bound_ctrl:0
v_add_f32_dpp v12, v12, v12 row_bcast:15 row_mask:0xa bank_mask:0xf
v_add_f32_dpp v13, v13, v13 row_bcast:15 row_mask:0xa bank_mask:0xf
v_add_f32_dpp v180, v180, v180 row_bcast:15 row_mask:0xa bank_mask:0xf
v_add_f32_dpp v181, v181, v181 row_bcast:15 row_mask:0xa bank_mask:0xf
v_add_f32_dpp v12, v12, v12 row_bcast:31 row_mask:0xc bank_mask:0xf
v_add_f32_dpp v13, v13, v13 row_bcast:31 row_mask:0xc bank_mask:0xf
v_add_f32_dpp v180, v180, v180 row_bcast:31 row_mask:0xc bank_mask:0xf
v_add_f32_dpp v181, v181, v181 row_bcast:31 row_mask:0xc bank_mask:0xf
v_mul_f32 v12, 0x3b124925, v12
v_mul_f32 v13, 0x3b124925, v13
v_mul_f32 v180, 0x3b124925, v180
v_mul_f32 v181, 0x3b124925, v181
v_fma_f32 v13, -v12, v12, v13
v_max_f32 v13, 0, v13
v_fma_f32 v181, -v180, v180, v181
v_max_f32 v181, 0, v181
v_cvt_pk_bf16_f32 v13, v13, v13
v_cvt_pk_bf16_f32 v181, v181, v181
v_and_b32 v13, 0xffff0000, v13
v_and_b32 v181, 0xffff0000, v181
v_add_f32 v13, 0x3727c5ac, v13
v_add_f32 v181, 0x3727c5ac, v181
v_cvt_pk_bf16_f32 v13, v13, v13
v_cvt_pk_bf16_f32 v181, v181, v181
v_and_b32 v13, 0xffff0000, v13
v_and_b32 v181, 0xffff0000, v181
v_sqrt_f32 v13, v13
v_sqrt_f32 v181, v181
v_cvt_pk_bf16_f32 v192, v12, v13
v_cvt_pk_bf16_f32 v194, v180, v181
v_xor_b32 v193, v192, v1
v_xor_b32 v195, v194, v1
s_lshl_b32 s89, s2, 3
s_sub_u32 s90, s3, 4
s_lshl_b32 s90, s90, 1
s_add_u32 s89, s89, s90
s_lshl_b32 s89, s89, 3
s_add_u32 s89, s89, 4096
s_mov_b32 exec_lo, 0
s_mov_b32 exec_hi, 0x80000000
buffer_store_dwordx4 v[192:195], v251, s[40:43], s89 offen sc1
s_mov_b64 exec, -1
s_waitcnt vmcnt(1)
s_sub_u32 s89, s3, 4
s_lshl_b32 s89, s89, 6
v_add_u32 v26, s89, v0
v_lshrrev_b32 v24, 4, v26
v_lshlrev_b32 v24, 13, v24
v_and_b32 v3, 15, v26
v_lshlrev_b32 v3, 4, v3
v_add_u32 v24, v24, v3
s_lshr_b32 s90, s84, 5
s_lshl_b32 s90, s90, 18
s_and_b32 s91, s84, 31
s_lshl_b32 s91, s91, 8
s_add_u32 s90, s90, s91
v_add_u32 v24, s90, v24
v_add_u32 v25, 131072, v24
s_lshl_b32 s89, s87, 16
s_and_b32 s90, s87, 0xffff0000
s_cmp_eq_u32 s85, 0
s_cselect_b32 s89, s89, s90
v_mov_b32 v22, s89
v_mul_f32 v22, 0x3fb8aa3b, v22
v_exp_f32 v22, v22
s_nop 0
v_cvt_pk_bf16_f32 v22, v22, v22
v_and_b32 v22, 0xffff0000, v22
v_lshlrev_b32 v28, 16, v16
v_and_b32 v29, 0xffff0000, v16
v_lshlrev_b32 v30, 16, v17
v_and_b32 v31, 0xffff0000, v17
v_mul_f32 v28, v22, v28
v_mul_f32 v29, v22, v29
v_mul_f32 v30, v22, v30
v_mul_f32 v31, v22, v31
v_mul_f32 v28, 0x3fb8aa3b, v28
v_mul_f32 v29, 0x3fb8aa3b, v29
v_mul_f32 v30, 0x3e22f983, v30
v_mul_f32 v31, 0x3e22f983, v31
v_mul_f32 v48, 0x41000000, v28
v_mul_f32 v49, 0x41000000, v30
v_exp_f32 v48, v48
v_fract_f32 v49, v49
s_nop 0
v_cos_f32 v36, v49
v_sin_f32 v37, v49
s_nop 0
v_mul_f32 v36, v48, v36
v_mul_f32_e64 v37, -v37, v48
v_mul_f32 v50, 0x41000000, v29
v_mul_f32 v51, 0x41000000, v31
v_exp_f32 v50, v50
v_fract_f32 v51, v51
s_nop 0
v_cos_f32 v38, v51
v_sin_f32 v39, v51
s_nop 0
v_mul_f32 v38, v50, v38
v_mul_f32_e64 v39, -v39, v50
s_lshl_b32 s89, s85, 1
s_add_u32 s89, s89, s86
s_add_u32 s89, s89, 4
s_mul_i32 s89, s89, 16896
v_lshlrev_b32 v60, 3, v0
v_add_u32 v60, s89, v60
v_mov_b32 v40, 0x3f80
v_mov_b32 v41, 0x3f80
ds_write_b64 v60, v[40:41]
v_cvt_pk_bf16_f32 v52, v36, v37
v_cvt_pk_bf16_f32 v53, v38, v39
ds_write_b64 v60, v[52:53] offset:528
v_lshlrev_b32 v27, 4, v26
s_mov_b32 s92, 4096
s_mov_b32 s93, 18874368
s_mov_b32 s94, 20971520
v_pk_mul_f32 v[200:201], v[36:37], v[36:37] op_sel_hi:[0,1]
v_pk_mul_f32 v[202:203], v[38:39], v[38:39] op_sel_hi:[0,1]
v_pk_fma_f32 v[200:201], v[36:37], v[36:37], v[200:201] op_sel:[1,1,0] op_sel_hi:[1,0,1] neg_lo:[1,0,0]
v_pk_fma_f32 v[202:203], v[38:39], v[38:39], v[202:203] op_sel:[1,1,0] op_sel_hi:[1,0,1] neg_lo:[1,0,0]
v_cvt_pk_bf16_f32 v54, v200, v201
v_cvt_pk_bf16_f32 v55, v202, v203
ds_write_b64 v60, v[54:55] offset:1056
v_pk_mul_f32 v[204:205], v[36:37], v[200:201] op_sel_hi:[0,1]
v_pk_mul_f32 v[206:207], v[38:39], v[202:203] op_sel_hi:[0,1]
v_pk_mul_f32 v[40:41], v[200:201], v[200:201] op_sel_hi:[0,1]
v_pk_mul_f32 v[42:43], v[202:203], v[202:203] op_sel_hi:[0,1]
v_pk_fma_f32 v[204:205], v[36:37], v[200:201], v[204:205] op_sel:[1,1,0] op_sel_hi:[1,0,1] neg_lo:[1,0,0]
v_pk_fma_f32 v[206:207], v[38:39], v[202:203], v[206:207] op_sel:[1,1,0] op_sel_hi:[1,0,1] neg_lo:[1,0,0]
v_pk_fma_f32 v[40:41], v[200:201], v[200:201], v[40:41] op_sel:[1,1,0] op_sel_hi:[1,0,1] neg_lo:[1,0,0]
v_pk_fma_f32 v[42:43], v[202:203], v[202:203], v[42:43] op_sel:[1,1,0] op_sel_hi:[1,0,1] neg_lo:[1,0,0]
v_cvt_pk_bf16_f32 v56, v204, v205
v_cvt_pk_bf16_f32 v57, v206, v207
ds_write_b64 v60, v[56:57] offset:1584
v_cvt_pk_bf16_f32 v58, v40, v41
v_cvt_pk_bf16_f32 v59, v42, v43
ds_write_b64 v60, v[58:59] offset:2112
v_pk_mul_f32 v[208:209], v[204:205], v[200:201] op_sel_hi:[0,1]
v_pk_mul_f32 v[210:211], v[206:207], v[202:203] op_sel_hi:[0,1]
v_pk_mul_f32 v[44:45], v[40:41], v[200:201] op_sel_hi:[0,1]
v_pk_mul_f32 v[46:47], v[42:43], v[202:203] op_sel_hi:[0,1]
v_pk_fma_f32 v[208:209], v[204:205], v[200:201], v[208:209] op_sel:[1,1,0] op_sel_hi:[1,0,1] neg_lo:[1,0,0]
v_pk_fma_f32 v[210:211], v[206:207], v[202:203], v[210:211] op_sel:[1,1,0] op_sel_hi:[1,0,1] neg_lo:[1,0,0]
v_pk_fma_f32 v[44:45], v[40:41], v[200:201], v[44:45] op_sel:[1,1,0] op_sel_hi:[1,0,1] neg_lo:[1,0,0]
v_pk_fma_f32 v[46:47], v[42:43], v[202:203], v[46:47] op_sel:[1,1,0] op_sel_hi:[1,0,1] neg_lo:[1,0,0]
v_cvt_pk_bf16_f32 v52, v208, v209
v_cvt_pk_bf16_f32 v53, v210, v211
ds_write_b64 v60, v[52:53] offset:2640
v_cvt_pk_bf16_f32 v54, v44, v45
v_cvt_pk_bf16_f32 v55, v46, v47
ds_write_b64 v60, v[54:55] offset:3168
v_pk_mul_f32 v[204:205], v[208:209], v[200:201] op_sel_hi:[0,1]
v_pk_mul_f32 v[206:207], v[210:211], v[202:203] op_sel_hi:[0,1]
v_pk_mul_f32 v[40:41], v[44:45], v[200:201] op_sel_hi:[0,1]
v_pk_mul_f32 v[42:43], v[46:47], v[202:203] op_sel_hi:[0,1]
v_pk_fma_f32 v[204:205], v[208:209], v[200:201], v[204:205] op_sel:[1,1,0] op_sel_hi:[1,0,1] neg_lo:[1,0,0]
v_pk_fma_f32 v[206:207], v[210:211], v[202:203], v[206:207] op_sel:[1,1,0] op_sel_hi:[1,0,1] neg_lo:[1,0,0]
v_pk_fma_f32 v[40:41], v[44:45], v[200:201], v[40:41] op_sel:[1,1,0] op_sel_hi:[1,0,1] neg_lo:[1,0,0]
v_pk_fma_f32 v[42:43], v[46:47], v[202:203], v[42:43] op_sel:[1,1,0] op_sel_hi:[1,0,1] neg_lo:[1,0,0]
v_cvt_pk_bf16_f32 v56, v204, v205
v_cvt_pk_bf16_f32 v57, v206, v207
ds_write_b64 v60, v[56:57] offset:3696
v_cvt_pk_bf16_f32 v58, v40, v41
v_cvt_pk_bf16_f32 v59, v42, v43
ds_write_b64 v60, v[58:59] offset:4224
v_pk_mul_f32 v[208:209], v[204:205], v[200:201] op_sel_hi:[0,1]
v_pk_mul_f32 v[210:211], v[206:207], v[202:203] op_sel_hi:[0,1]
v_pk_mul_f32 v[44:45], v[40:41], v[200:201] op_sel_hi:[0,1]
v_pk_mul_f32 v[46:47], v[42:43], v[202:203] op_sel_hi:[0,1]
v_pk_fma_f32 v[208:209], v[204:205], v[200:201], v[208:209] op_sel:[1,1,0] op_sel_hi:[1,0,1] neg_lo:[1,0,0]
v_pk_fma_f32 v[210:211], v[206:207], v[202:203], v[210:211] op_sel:[1,1,0] op_sel_hi:[1,0,1] neg_lo:[1,0,0]
v_pk_fma_f32 v[44:45], v[40:41], v[200:201], v[44:45] op_sel:[1,1,0] op_sel_hi:[1,0,1] neg_lo:[1,0,0]
v_pk_fma_f32 v[46:47], v[42:43], v[202:203], v[46:47] op_sel:[1,1,0] op_sel_hi:[1,0,1] neg_lo:[1,0,0]
v_cvt_pk_bf16_f32 v52, v208, v209
v_cvt_pk_bf16_f32 v53, v210, v211
ds_write_b64 v60, v[52:53] offset:4752
v_cvt_pk_bf16_f32 v54, v44, v45
v_cvt_pk_bf16_f32 v55, v46, v47
ds_write_b64 v60, v[54:55] offset:5280
v_pk_mul_f32 v[204:205], v[208:209], v[200:201] op_sel_hi:[0,1]
v_pk_mul_f32 v[206:207], v[210:211], v[202:203] op_sel_hi:[0,1]
v_pk_mul_f32 v[40:41], v[44:45], v[200:201] op_sel_hi:[0,1]
v_pk_mul_f32 v[42:43], v[46:47], v[202:203] op_sel_hi:[0,1]
v_pk_fma_f32 v[204:205], v[208:209], v[200:201], v[204:205] op_sel:[1,1,0] op_sel_hi:[1,0,1] neg_lo:[1,0,0]
v_pk_fma_f32 v[206:207], v[210:211], v[202:203], v[206:207] op_sel:[1,1,0] op_sel_hi:[1,0,1] neg_lo:[1,0,0]
v_pk_fma_f32 v[40:41], v[44:45], v[200:201], v[40:41] op_sel:[1,1,0] op_sel_hi:[1,0,1] neg_lo:[1,0,0]
v_pk_fma_f32 v[42:43], v[46:47], v[202:203], v[42:43] op_sel:[1,1,0] op_sel_hi:[1,0,1] neg_lo:[1,0,0]
v_cvt_pk_bf16_f32 v56, v204, v205
v_cvt_pk_bf16_f32 v57, v206, v207
ds_write_b64 v60, v[56:57] offset:5808
v_cvt_pk_bf16_f32 v58, v40, v41
v_cvt_pk_bf16_f32 v59, v42, v43
ds_write_b64 v60, v[58:59] offset:6336
v_pk_mul_f32 v[208:209], v[204:205], v[200:201] op_sel_hi:[0,1]
v_pk_mul_f32 v[210:211], v[206:207], v[202:203] op_sel_hi:[0,1]
v_pk_mul_f32 v[44:45], v[40:41], v[200:201] op_sel_hi:[0,1]
v_pk_mul_f32 v[46:47], v[42:43], v[202:203] op_sel_hi:[0,1]
v_pk_fma_f32 v[208:209], v[204:205], v[200:201], v[208:209] op_sel:[1,1,0] op_sel_hi:[1,0,1] neg_lo:[1,0,0]
v_pk_fma_f32 v[210:211], v[206:207], v[202:203], v[210:211] op_sel:[1,1,0] op_sel_hi:[1,0,1] neg_lo:[1,0,0]
v_pk_fma_f32 v[44:45], v[40:41], v[200:201], v[44:45] op_sel:[1,1,0] op_sel_hi:[1,0,1] neg_lo:[1,0,0]
v_pk_fma_f32 v[46:47], v[42:43], v[202:203], v[46:47] op_sel:[1,1,0] op_sel_hi:[1,0,1] neg_lo:[1,0,0]
v_cvt_pk_bf16_f32 v52, v208, v209
v_cvt_pk_bf16_f32 v53, v210, v211
ds_write_b64 v60, v[52:53] offset:6864
v_cvt_pk_bf16_f32 v54, v44, v45
v_cvt_pk_bf16_f32 v55, v46, v47
ds_write_b64 v60, v[54:55] offset:7392
v_pk_mul_f32 v[204:205], v[208:209], v[200:201] op_sel_hi:[0,1]
v_pk_mul_f32 v[206:207], v[210:211], v[202:203] op_sel_hi:[0,1]
v_pk_mul_f32 v[40:41], v[44:45], v[200:201] op_sel_hi:[0,1]
v_pk_mul_f32 v[42:43], v[46:47], v[202:203] op_sel_hi:[0,1]
v_pk_fma_f32 v[204:205], v[208:209], v[200:201], v[204:205] op_sel:[1,1,0] op_sel_hi:[1,0,1] neg_lo:[1,0,0]
v_pk_fma_f32 v[206:207], v[210:211], v[202:203], v[206:207] op_sel:[1,1,0] op_sel_hi:[1,0,1] neg_lo:[1,0,0]
v_pk_fma_f32 v[40:41], v[44:45], v[200:201], v[40:41] op_sel:[1,1,0] op_sel_hi:[1,0,1] neg_lo:[1,0,0]
v_pk_fma_f32 v[42:43], v[46:47], v[202:203], v[42:43] op_sel:[1,1,0] op_sel_hi:[1,0,1] neg_lo:[1,0,0]
v_cvt_pk_bf16_f32 v56, v204, v205
v_cvt_pk_bf16_f32 v57, v206, v207
ds_write_b64 v60, v[56:57] offset:7920
v_cvt_pk_bf16_f32 v58, v40, v41
v_cvt_pk_bf16_f32 v59, v42, v43
ds_write_b64 v60, v[58:59] offset:8448
v_pk_mul_f32 v[208:209], v[204:205], v[200:201] op_sel_hi:[0,1]
v_pk_mul_f32 v[210:211], v[206:207], v[202:203] op_sel_hi:[0,1]
v_pk_mul_f32 v[44:45], v[40:41], v[200:201] op_sel_hi:[0,1]
v_pk_mul_f32 v[46:47], v[42:43], v[202:203] op_sel_hi:[0,1]
v_pk_fma_f32 v[208:209], v[204:205], v[200:201], v[208:209] op_sel:[1,1,0] op_sel_hi:[1,0,1] neg_lo:[1,0,0]
v_pk_fma_f32 v[210:211], v[206:207], v[202:203], v[210:211] op_sel:[1,1,0] op_sel_hi:[1,0,1] neg_lo:[1,0,0]
v_pk_fma_f32 v[44:45], v[40:41], v[200:201], v[44:45] op_sel:[1,1,0] op_sel_hi:[1,0,1] neg_lo:[1,0,0]
v_pk_fma_f32 v[46:47], v[42:43], v[202:203], v[46:47] op_sel:[1,1,0] op_sel_hi:[1,0,1] neg_lo:[1,0,0]
v_cvt_pk_bf16_f32 v52, v208, v209
v_cvt_pk_bf16_f32 v53, v210, v211
ds_write_b64 v60, v[52:53] offset:8976
v_cvt_pk_bf16_f32 v54, v44, v45
v_cvt_pk_bf16_f32 v55, v46, v47
ds_write_b64 v60, v[54:55] offset:9504
v_pk_mul_f32 v[204:205], v[208:209], v[200:201] op_sel_hi:[0,1]
v_pk_mul_f32 v[206:207], v[210:211], v[202:203] op_sel_hi:[0,1]
v_pk_mul_f32 v[40:41], v[44:45], v[200:201] op_sel_hi:[0,1]
v_pk_mul_f32 v[42:43], v[46:47], v[202:203] op_sel_hi:[0,1]
v_pk_fma_f32 v[204:205], v[208:209], v[200:201], v[204:205] op_sel:[1,1,0] op_sel_hi:[1,0,1] neg_lo:[1,0,0]
v_pk_fma_f32 v[206:207], v[210:211], v[202:203], v[206:207] op_sel:[1,1,0] op_sel_hi:[1,0,1] neg_lo:[1,0,0]
v_pk_fma_f32 v[40:41], v[44:45], v[200:201], v[40:41] op_sel:[1,1,0] op_sel_hi:[1,0,1] neg_lo:[1,0,0]
v_pk_fma_f32 v[42:43], v[46:47], v[202:203], v[42:43] op_sel:[1,1,0] op_sel_hi:[1,0,1] neg_lo:[1,0,0]
v_cvt_pk_bf16_f32 v56, v204, v205
v_cvt_pk_bf16_f32 v57, v206, v207
ds_write_b64 v60, v[56:57] offset:10032
v_cvt_pk_bf16_f32 v58, v40, v41
v_cvt_pk_bf16_f32 v59, v42, v43
ds_write_b64 v60, v[58:59] offset:10560
v_pk_mul_f32 v[208:209], v[204:205], v[200:201] op_sel_hi:[0,1]
v_pk_mul_f32 v[210:211], v[206:207], v[202:203] op_sel_hi:[0,1]
v_pk_mul_f32 v[44:45], v[40:41], v[200:201] op_sel_hi:[0,1]
v_pk_mul_f32 v[46:47], v[42:43], v[202:203] op_sel_hi:[0,1]
v_pk_fma_f32 v[208:209], v[204:205], v[200:201], v[208:209] op_sel:[1,1,0] op_sel_hi:[1,0,1] neg_lo:[1,0,0]
v_pk_fma_f32 v[210:211], v[206:207], v[202:203], v[210:211] op_sel:[1,1,0] op_sel_hi:[1,0,1] neg_lo:[1,0,0]
v_pk_fma_f32 v[44:45], v[40:41], v[200:201], v[44:45] op_sel:[1,1,0] op_sel_hi:[1,0,1] neg_lo:[1,0,0]
v_pk_fma_f32 v[46:47], v[42:43], v[202:203], v[46:47] op_sel:[1,1,0] op_sel_hi:[1,0,1] neg_lo:[1,0,0]
v_cvt_pk_bf16_f32 v52, v208, v209
v_cvt_pk_bf16_f32 v53, v210, v211
ds_write_b64 v60, v[52:53] offset:11088
v_cvt_pk_bf16_f32 v54, v44, v45
v_cvt_pk_bf16_f32 v55, v46, v47
ds_write_b64 v60, v[54:55] offset:11616
v_pk_mul_f32 v[204:205], v[208:209], v[200:201] op_sel_hi:[0,1]
v_pk_mul_f32 v[206:207], v[210:211], v[202:203] op_sel_hi:[0,1]
v_pk_mul_f32 v[40:41], v[44:45], v[200:201] op_sel_hi:[0,1]
v_pk_mul_f32 v[42:43], v[46:47], v[202:203] op_sel_hi:[0,1]
v_pk_fma_f32 v[204:205], v[208:209], v[200:201], v[204:205] op_sel:[1,1,0] op_sel_hi:[1,0,1] neg_lo:[1,0,0]
v_pk_fma_f32 v[206:207], v[210:211], v[202:203], v[206:207] op_sel:[1,1,0] op_sel_hi:[1,0,1] neg_lo:[1,0,0]
v_pk_fma_f32 v[40:41], v[44:45], v[200:201], v[40:41] op_sel:[1,1,0] op_sel_hi:[1,0,1] neg_lo:[1,0,0]
v_pk_fma_f32 v[42:43], v[46:47], v[202:203], v[42:43] op_sel:[1,1,0] op_sel_hi:[1,0,1] neg_lo:[1,0,0]
v_cvt_pk_bf16_f32 v56, v204, v205
v_cvt_pk_bf16_f32 v57, v206, v207
ds_write_b64 v60, v[56:57] offset:12144
v_cvt_pk_bf16_f32 v58, v40, v41
v_cvt_pk_bf16_f32 v59, v42, v43
ds_write_b64 v60, v[58:59] offset:12672
v_pk_mul_f32 v[208:209], v[204:205], v[200:201] op_sel_hi:[0,1]
v_pk_mul_f32 v[210:211], v[206:207], v[202:203] op_sel_hi:[0,1]
v_pk_mul_f32 v[44:45], v[40:41], v[200:201] op_sel_hi:[0,1]
v_pk_mul_f32 v[46:47], v[42:43], v[202:203] op_sel_hi:[0,1]
v_pk_fma_f32 v[208:209], v[204:205], v[200:201], v[208:209] op_sel:[1,1,0] op_sel_hi:[1,0,1] neg_lo:[1,0,0]
v_pk_fma_f32 v[210:211], v[206:207], v[202:203], v[210:211] op_sel:[1,1,0] op_sel_hi:[1,0,1] neg_lo:[1,0,0]
v_pk_fma_f32 v[44:45], v[40:41], v[200:201], v[44:45] op_sel:[1,1,0] op_sel_hi:[1,0,1] neg_lo:[1,0,0]
v_pk_fma_f32 v[46:47], v[42:43], v[202:203], v[46:47] op_sel:[1,1,0] op_sel_hi:[1,0,1] neg_lo:[1,0,0]
v_cvt_pk_bf16_f32 v52, v208, v209
v_cvt_pk_bf16_f32 v53, v210, v211
ds_write_b64 v60, v[52:53] offset:13200
v_cvt_pk_bf16_f32 v54, v44, v45
v_cvt_pk_bf16_f32 v55, v46, v47
ds_write_b64 v60, v[54:55] offset:13728
v_pk_mul_f32 v[204:205], v[208:209], v[200:201] op_sel_hi:[0,1]
v_pk_mul_f32 v[206:207], v[210:211], v[202:203] op_sel_hi:[0,1]
v_pk_mul_f32 v[40:41], v[44:45], v[200:201] op_sel_hi:[0,1]
v_pk_mul_f32 v[42:43], v[46:47], v[202:203] op_sel_hi:[0,1]
v_pk_fma_f32 v[204:205], v[208:209], v[200:201], v[204:205] op_sel:[1,1,0] op_sel_hi:[1,0,1] neg_lo:[1,0,0]
v_pk_fma_f32 v[206:207], v[210:211], v[202:203], v[206:207] op_sel:[1,1,0] op_sel_hi:[1,0,1] neg_lo:[1,0,0]
v_pk_fma_f32 v[40:41], v[44:45], v[200:201], v[40:41] op_sel:[1,1,0] op_sel_hi:[1,0,1] neg_lo:[1,0,0]
v_pk_fma_f32 v[42:43], v[46:47], v[202:203], v[42:43] op_sel:[1,1,0] op_sel_hi:[1,0,1] neg_lo:[1,0,0]
v_cvt_pk_bf16_f32 v56, v204, v205
v_cvt_pk_bf16_f32 v57, v206, v207
ds_write_b64 v60, v[56:57] offset:14256
v_cvt_pk_bf16_f32 v58, v40, v41
v_cvt_pk_bf16_f32 v59, v42, v43
ds_write_b64 v60, v[58:59] offset:14784
buffer_load_dwordx4 v[64:67], v27, s[40:43], s92 offen sc1
s_add_u32 s92, s92, 4096
buffer_load_dwordx4 v[68:71], v27, s[40:43], s92 offen sc1
s_add_u32 s92, s92, 4096
buffer_load_dwordx4 v[72:75], v27, s[40:43], s92 offen sc1
s_add_u32 s92, s92, 4096
buffer_load_dwordx4 v[76:79], v27, s[40:43], s92 offen sc1
s_mov_b32 s92, 4096
buffer_load_dwordx4 v[128:131], v24, s[40:43], s93 offen sc1
buffer_load_dwordx4 v[132:135], v25, s[40:43], s93 offen sc1
buffer_load_dwordx4 v[136:139], v24, s[40:43], s94 offen sc1
buffer_load_dwordx4 v[140:143], v25, s[40:43], s94 offen sc1
v_pk_mul_f32 v[208:209], v[204:205], v[200:201] op_sel_hi:[0,1]
v_pk_mul_f32 v[210:211], v[206:207], v[202:203] op_sel_hi:[0,1]
v_pk_mul_f32 v[44:45], v[40:41], v[200:201] op_sel_hi:[0,1]
v_pk_mul_f32 v[46:47], v[42:43], v[202:203] op_sel_hi:[0,1]
v_pk_fma_f32 v[208:209], v[204:205], v[200:201], v[208:209] op_sel:[1,1,0] op_sel_hi:[1,0,1] neg_lo:[1,0,0]
v_pk_fma_f32 v[210:211], v[206:207], v[202:203], v[210:211] op_sel:[1,1,0] op_sel_hi:[1,0,1] neg_lo:[1,0,0]
v_pk_fma_f32 v[44:45], v[40:41], v[200:201], v[44:45] op_sel:[1,1,0] op_sel_hi:[1,0,1] neg_lo:[1,0,0]
v_pk_fma_f32 v[46:47], v[42:43], v[202:203], v[46:47] op_sel:[1,1,0] op_sel_hi:[1,0,1] neg_lo:[1,0,0]
v_cvt_pk_bf16_f32 v52, v208, v209
v_cvt_pk_bf16_f32 v53, v210, v211
ds_write_b64 v60, v[52:53] offset:15312
v_cvt_pk_bf16_f32 v54, v44, v45
v_cvt_pk_bf16_f32 v55, v46, v47
ds_write_b64 v60, v[54:55] offset:15840
v_pk_mul_f32 v[204:205], v[208:209], v[200:201] op_sel_hi:[0,1]
v_pk_mul_f32 v[206:207], v[210:211], v[202:203] op_sel_hi:[0,1]
v_pk_fma_f32 v[204:205], v[208:209], v[200:201], v[204:205] op_sel:[1,1,0] op_sel_hi:[1,0,1] neg_lo:[1,0,0]
v_pk_fma_f32 v[206:207], v[210:211], v[202:203], v[206:207] op_sel:[1,1,0] op_sel_hi:[1,0,1] neg_lo:[1,0,0]
v_cvt_pk_bf16_f32 v56, v204, v205
v_cvt_pk_bf16_f32 v57, v206, v207
ds_write_b64 v60, v[56:57] offset:16368
v_lshrrev_b32 v3, 3, v0
v_and_b32 v4, 7, v0
v_lshlrev_b32 v4, 4, v4
v_mul_u32_u24 v20, 3584, v3
v_add_u32 v20, v20, v4
v_mul_u32_u24 v21, 896, v3
v_add_u32 v21, v21, v4
s_mul_i32 s90, s54, 57344
s_lshl_b32 s91, s53, 7
s_add_u32 s90, s90, s91
s_add_u32 s91, s90, 28672
buffer_load_dwordx4 v[144:147], v20, s[68:71], s90 offen
buffer_load_dwordx4 v[148:151], v20, s[68:71], s91 offen
buffer_load_dwordx4 v[152:155], v20, s[72:75], s90 offen
buffer_load_dwordx4 v[156:159], v20, s[72:75], s91 offen
s_mul_i32 s90, s55, 14336
s_lshl_b32 s91, s56, 7
s_add_u32 s90, s90, s91
s_add_u32 s91, s90, 7168
buffer_load_dwordx4 v[160:163], v21, s[76:79], s90 offen
buffer_load_dwordx4 v[164:167], v21, s[76:79], s91 offen
s_waitcnt lgkmcnt(0)
s_barrier
v_lshrrev_b32 v3, 5, v0
v_mul_u32_u24 v3, 4608, v3
v_and_b32 v4, 31, v0
v_lshlrev_b32 v4, 4, v4
v_add_u32 v3, v3, v4
v_add_u32 v3, 135168, v3
v_mov_b32 v52, 0
v_mov_b32 v53, 0
v_mov_b32 v54, 0
v_mov_b32 v55, 0
ds_write_b128 v3, v[52:55]
s_mov_b32 s90, 0
s_waitcnt vmcnt(6)
LN_chk:
v_xor_b32 v80, v65, v64
v_xor_b32 v81, v67, v66
v_xor_b32 v82, v69, v68
v_xor_b32 v83, v71, v70
v_xor_b32 v84, v73, v72
v_xor_b32 v85, v75, v74
v_xor_b32 v86, v77, v76
v_xor_b32 v87, v79, v78
v_xor_b32 v88, v128, v136
v_xor_b32 v89, v129, v137
v_xor_b32 v90, v130, v138
v_xor_b32 v91, v131, v139
v_xor_b32 v92, v132, v140
v_xor_b32 v93, v133, v141
v_xor_b32 v94, v134, v142
v_xor_b32 v95, v135, v143
v_xor_b32 v80, v80, v1
v_xor_b32 v81, v81, v1
v_xor_b32 v82, v82, v1
v_xor_b32 v83, v83, v1
v_xor_b32 v84, v84, v1
v_xor_b32 v85, v85, v1
v_xor_b32 v86, v86, v1
v_xor_b32 v87, v87, v1
v_xor_b32 v88, v88, v1
v_xor_b32 v89, v89, v1
v_xor_b32 v90, v90, v1
v_xor_b32 v91, v91, v1
v_xor_b32 v92, v92, v1
v_xor_b32 v93, v93, v1
v_xor_b32 v94, v94, v1
v_xor_b32 v95, v95, v1
v_or3_b32 v80, v80, v81, v82
v_or3_b32 v83, v83, v84, v85
v_or3_b32 v86, v86, v87, v88
v_or3_b32 v89, v89, v90, v91
v_or3_b32 v92, v92, v93, v94
v_or3_b32 v80, v80, v83, v86
v_or3_b32 v89, v89, v92, v95
v_or_b32 v80, v80, v89
v_cmp_ne_u32 vcc, 0, v80
s_cbranch_vccz LN_got
s_add_u32 s90, s90, 1
s_cmp_lt_u32 s90, 0x40000
s_cbranch_scc0 LN_got
s_mov_b64 exec, vcc
buffer_load_dwordx4 v[64:67], v27, s[40:43], s92 offen sc1
s_add_u32 s92, s92, 4096
buffer_load_dwordx4 v[68:71], v27, s[40:43], s92 offen sc1
s_add_u32 s92, s92, 4096
buffer_load_dwordx4 v[72:75], v27, s[40:43], s92 offen sc1
s_add_u32 s92, s92, 4096
buffer_load_dwordx4 v[76:79], v27, s[40:43], s92 offen sc1
s_mov_b32 s92, 4096
buffer_load_dwordx4 v[128:131], v24, s[40:43], s93 offen sc1
buffer_load_dwordx4 v[132:135], v25, s[40:43], s93 offen sc1
buffer_load_dwordx4 v[136:139], v24, s[40:43], s94 offen sc1
buffer_load_dwordx4 v[140:143], v25, s[40:43], s94 offen sc1
s_waitcnt vmcnt(0)
s_branch LN_chk
LN_got:
s_mov_b64 exec, -1
v_lshlrev_b32 v3, 4, v26
v_add_u32 v3, 144384, v3
v_and_b32 v65, 0xffff0000, v64
v_and_b32 v67, 0xffff0000, v66
v_lshlrev_b32 v64, 16, v64
v_lshlrev_b32 v66, 16, v66
v_rcp_f32 v65, v65
v_rcp_f32 v67, v67
v_and_b32 v69, 0xffff0000, v68
v_and_b32 v71, 0xffff0000, v70
v_lshlrev_b32 v68, 16, v68
v_lshlrev_b32 v70, 16, v70
v_rcp_f32 v69, v69
v_rcp_f32 v71, v71
v_and_b32 v73, 0xffff0000, v72
v_and_b32 v75, 0xffff0000, v74
v_lshlrev_b32 v72, 16, v72
v_lshlrev_b32 v74, 16, v74
v_rcp_f32 v73, v73
v_rcp_f32 v75, v75
v_and_b32 v77, 0xffff0000, v76
v_and_b32 v79, 0xffff0000, v78
v_lshlrev_b32 v76, 16, v76
v_lshlrev_b32 v78, 16, v78
v_rcp_f32 v77, v77
v_rcp_f32 v79, v79
v_mul_f32_e64 v64, -v64, v65
v_mul_f32_e64 v66, -v66, v67
ds_write_b128 v3, v[64:67] offset:0
v_mul_f32_e64 v68, -v68, v69
v_mul_f32_e64 v70, -v70, v71
ds_write_b128 v3, v[68:71] offset:4096
v_mul_f32_e64 v72, -v72, v73
v_mul_f32_e64 v74, -v74, v75
ds_write_b128 v3, v[72:75] offset:8192
v_mul_f32_e64 v76, -v76, v77
v_mul_f32_e64 v78, -v78, v79
ds_write_b128 v3, v[76:79] offset:12288
v_lshlrev_b32 v96, 16, v128
v_and_b32 v97, 0xffff0000, v128
v_lshlrev_b32 v98, 16, v129
v_and_b32 v99, 0xffff0000, v129
v_lshlrev_b32 v100, 16, v130
v_and_b32 v101, 0xffff0000, v130
v_lshlrev_b32 v102, 16, v131
v_and_b32 v103, 0xffff0000, v131
v_lshlrev_b32 v104, 16, v132
v_and_b32 v105, 0xffff0000, v132
v_lshlrev_b32 v106, 16, v133
v_and_b32 v107, 0xffff0000, v133
v_lshlrev_b32 v108, 16, v134
v_and_b32 v109, 0xffff0000, v134
v_lshlrev_b32 v110, 16, v135
v_and_b32 v111, 0xffff0000, v135
v_lshrrev_b32 v22, 4, v26
v_lshlrev_b32 v22, 6, v22
v_and_b32 v3, 7, v26
v_lshlrev_b32 v3, 3, v3
v_add_u32 v22, v22, v3
v_bfe_u32 v23, v26, 3, 1
v_lshlrev_b32 v21, 3, v22
v_add_u32 v21, 144384, v21
s_waitcnt lgkmcnt(0)
s_barrier
ds_read_b128 v[64:67], v21 offset:0
ds_read_b128 v[68:71], v21 offset:16
ds_read_b128 v[72:75], v21 offset:32
ds_read_b128 v[76:79], v21 offset:48
ds_read_b128 v[80:83], v21 offset:8192
ds_read_b128 v[84:87], v21 offset:8208
ds_read_b128 v[88:91], v21 offset:8224
ds_read_b128 v[92:95], v21 offset:8240
v_mul_u32_u24 v4, 4608, v23
v_lshlrev_b32 v7, 1, v22
v_add_u32 v4, v4, v7
v_add_u32 v4, 135680, v4
s_waitcnt lgkmcnt(4)
v_fma_f32 v96, v96, v65, v64
v_fma_f32 v97, v97, v67, v66
v_fma_f32 v98, v98, v69, v68
v_fma_f32 v99, v99, v71, v70
v_fma_f32 v100, v100, v73, v72
v_fma_f32 v101, v101, v75, v74
v_fma_f32 v102, v102, v77, v76
v_fma_f32 v103, v103, v79, v78
v_cvt_pk_bf16_f32 v120, v96, v97
v_cvt_pk_bf16_f32 v121, v98, v99
v_cvt_pk_bf16_f32 v122, v100, v101
v_cvt_pk_bf16_f32 v123, v102, v103
ds_write_b128 v4, v[120:123] offset:0
s_waitcnt lgkmcnt(1)
v_fma_f32 v104, v104, v81, v80
v_fma_f32 v105, v105, v83, v82
v_fma_f32 v106, v106, v85, v84
v_fma_f32 v107, v107, v87, v86
v_fma_f32 v108, v108, v89, v88
v_fma_f32 v109, v109, v91, v90
v_fma_f32 v110, v110, v93, v92
v_fma_f32 v111, v111, v95, v94
v_cvt_pk_bf16_f32 v124, v104, v105
v_cvt_pk_bf16_f32 v125, v106, v107
v_cvt_pk_bf16_f32 v126, v108, v109
v_cvt_pk_bf16_f32 v127, v110, v111
ds_write_b128 v4, v[124:127] offset:2048
s_waitcnt lgkmcnt(0)
s_barrier
v_lshlrev_b32 v4, 12, v23
v_lshlrev_b32 v7, 1, v22
v_add_u32 v4, v4, v7
v_add_u32 v4, 144384, v4
ds_write_b128 v4, v[128:131] offset:0
ds_write_b128 v4, v[132:135] offset:2048
s_cmp_ge_u32 s52, 784
s_cbranch_scc1 LN_norep2
v_lshlrev_b32 v3, 4, v0
v_add_u32 v4, s57, v3
s_waitcnt vmcnt(0)
ds_write_b128 v4, v[144:147] offset:0
ds_write_b128 v4, v[148:151] offset:1024
ds_write_b128 v4, v[152:155] offset:2048
ds_write_b128 v4, v[156:159] offset:3072
ds_write_b128 v4, v[160:163] offset:4096
ds_write_b128 v4, v[164:167] offset:5120
v_lshrrev_b32 v20, 4, v0
v_bfe_u32 v21, v0, 2, 2
v_and_b32 v22, 3, v0
v_and_b32 v7, 1, v20
v_lshlrev_b32 v7, 11, v7
v_lshrrev_b32 v4, 1, v20
v_lshlrev_b32 v4, 10, v4
v_add_u32 v7, v7, v4
v_lshlrev_b32 v4, 7, v21
v_add_u32 v7, v7, v4
v_lshlrev_b32 v4, 3, v22
v_add3_u32 v18, v7, v4, s57
v_lshrrev_b32 v7, 1, v20
v_lshlrev_b32 v7, 9, v7
v_lshlrev_b32 v4, 7, v21
v_add_u32 v7, v7, v4
v_and_b32 v4, 1, v20
v_lshlrev_b32 v4, 5, v4
v_add_u32 v7, v7, v4
v_lshlrev_b32 v4, 3, v22
v_add3_u32 v19, v7, v4, s57
s_waitcnt lgkmcnt(0)
ds_read_b64_tr_b16 v[32:33], v18 offset:0
ds_read_b64_tr_b16 v[34:35], v18 offset:512
ds_read_b64_tr_b16 v[36:37], v18 offset:32
ds_read_b64_tr_b16 v[38:39], v18 offset:544
ds_read_b64_tr_b16 v[40:41], v18 offset:64
ds_read_b64_tr_b16 v[42:43], v18 offset:576
ds_read_b64_tr_b16 v[44:45], v18 offset:96
ds_read_b64_tr_b16 v[46:47], v18 offset:608
ds_read_b64_tr_b16 v[48:49], v19 offset:4096
ds_read_b64_tr_b16 v[50:51], v19 offset:5120
ds_read_b64_tr_b16 v[52:53], v19 offset:4160
ds_read_b64_tr_b16 v[54:55], v19 offset:5184
s_mul_i32 s90, s53, 116
s_add_u32 s90, s90, s54
s_lshl_b32 s90, s90, 10
s_add_u32 s90, s90, 4194304
s_waitcnt lgkmcnt(0)
buffer_store_dwordx4 v[32:35], v3, s[40:43], s90 offen sc1
s_add_u32 s90, s90, 29696
buffer_store_dwordx4 v[36:39], v3, s[40:43], s90 offen sc1
s_add_u32 s90, s90, 29696
buffer_store_dwordx4 v[40:43], v3, s[40:43], s90 offen sc1
s_add_u32 s90, s90, 29696
buffer_store_dwordx4 v[44:47], v3, s[40:43], s90 offen sc1
s_mul_i32 s90, s56, 224
s_add_u32 s90, s90, s55
s_lshl_b32 s90, s90, 10
s_add_u32 s90, s90, 8388608
buffer_store_dwordx4 v[48:51], v3, s[40:43], s90 offen sc1
s_add_u32 s90, s90, 114688
buffer_store_dwordx4 v[52:55], v3, s[40:43], s90 offen sc1
LN_norep2:
s_waitcnt lgkmcnt(0)
s_barrier
s_endpgm
LA_spare:
s_cmp_ge_u32 s3, 4
s_cbranch_scc1 LS_prodd
s_waitcnt vmcnt(1)
s_mov_b32 s89, 0x9E3779B1
v_mul_lo_u32 v1, v2, s89
v_add_u32 v1, 0x7F4A7C15, v1
v_mov_b32 v12, 0
v_mov_b32 v13, 0
v_mov_b32 v180, 0
v_mov_b32 v181, 0
v_mov_b32 v4, 0x3f803f80
v_dot2c_f32_bf16 v12, v8, v4
v_dot2c_f32_bf16 v13, v8, v8
v_dot2c_f32_bf16 v180, v168, v4
v_dot2c_f32_bf16 v181, v168, v168
v_dot2c_f32_bf16 v12, v9, v4
v_dot2c_f32_bf16 v13, v9, v9
v_dot2c_f32_bf16 v180, v169, v4
v_dot2c_f32_bf16 v181, v169, v169
v_dot2c_f32_bf16 v12, v10, v4
v_dot2c_f32_bf16 v13, v10, v10
v_dot2c_f32_bf16 v180, v170, v4
v_dot2c_f32_bf16 v181, v170, v170
v_dot2c_f32_bf16 v12, v11, v4
v_dot2c_f32_bf16 v13, v11, v11
v_dot2c_f32_bf16 v180, v171, v4
v_dot2c_f32_bf16 v181, v171, v171
s_nop 2
v_add_f32_dpp v12, v12, v12 row_shr:1 row_mask:0xf bank_mask:0xf bound_ctrl:0
v_add_f32_dpp v13, v13, v13 row_shr:1 row_mask:0xf bank_mask:0xf bound_ctrl:0
v_add_f32_dpp v180, v180, v180 row_shr:1 row_mask:0xf bank_mask:0xf bound_ctrl:0
v_add_f32_dpp v181, v181, v181 row_shr:1 row_mask:0xf bank_mask:0xf bound_ctrl:0
v_add_f32_dpp v12, v12, v12 row_shr:2 row_mask:0xf bank_mask:0xf bound_ctrl:0
v_add_f32_dpp v13, v13, v13 row_shr:2 row_mask:0xf bank_mask:0xf bound_ctrl:0
v_add_f32_dpp v180, v180, v180 row_shr:2 row_mask:0xf bank_mask:0xf bound_ctrl:0
v_add_f32_dpp v181, v181, v181 row_shr:2 row_mask:0xf bank_mask:0xf bound_ctrl:0
v_add_f32_dpp v12, v12, v12 row_shr:4 row_mask:0xf bank_mask:0xf bound_ctrl:0
v_add_f32_dpp v13, v13, v13 row_shr:4 row_mask:0xf bank_mask:0xf bound_ctrl:0
v_add_f32_dpp v180, v180, v180 row_shr:4 row_mask:0xf bank_mask:0xf bound_ctrl:0
v_add_f32_dpp v181, v181, v181 row_shr:4 row_mask:0xf bank_mask:0xf bound_ctrl:0
v_add_f32_dpp v12, v12, v12 row_shr:8 row_mask:0xf bank_mask:0xf bound_ctrl:0
v_add_f32_dpp v13, v13, v13 row_shr:8 row_mask:0xf bank_mask:0xf bound_ctrl:0
v_add_f32_dpp v180, v180, v180 row_shr:8 row_mask:0xf bank_mask:0xf bound_ctrl:0
v_add_f32_dpp v181, v181, v181 row_shr:8 row_mask:0xf bank_mask:0xf bound_ctrl:0
v_add_f32_dpp v12, v12, v12 row_bcast:15 row_mask:0xa bank_mask:0xf
v_add_f32_dpp v13, v13, v13 row_bcast:15 row_mask:0xa bank_mask:0xf
v_add_f32_dpp v180, v180, v180 row_bcast:15 row_mask:0xa bank_mask:0xf
v_add_f32_dpp v181, v181, v181 row_bcast:15 row_mask:0xa bank_mask:0xf
v_add_f32_dpp v12, v12, v12 row_bcast:31 row_mask:0xc bank_mask:0xf
v_add_f32_dpp v13, v13, v13 row_bcast:31 row_mask:0xc bank_mask:0xf
v_add_f32_dpp v180, v180, v180 row_bcast:31 row_mask:0xc bank_mask:0xf
v_add_f32_dpp v181, v181, v181 row_bcast:31 row_mask:0xc bank_mask:0xf
v_mul_f32 v12, 0x3b124925, v12
v_mul_f32 v13, 0x3b124925, v13
v_mul_f32 v180, 0x3b124925, v180
v_mul_f32 v181, 0x3b124925, v181
v_fma_f32 v13, -v12, v12, v13
v_max_f32 v13, 0, v13
v_fma_f32 v181, -v180, v180, v181
v_max_f32 v181, 0, v181
v_cvt_pk_bf16_f32 v13, v13, v13
v_cvt_pk_bf16_f32 v181, v181, v181
v_and_b32 v13, 0xffff0000, v13
v_and_b32 v181, 0xffff0000, v181
v_add_f32 v13, 0x3727c5ac, v13
v_add_f32 v181, 0x3727c5ac, v181
v_cvt_pk_bf16_f32 v13, v13, v13
v_cvt_pk_bf16_f32 v181, v181, v181
v_and_b32 v13, 0xffff0000, v13
v_and_b32 v181, 0xffff0000, v181
v_sqrt_f32 v13, v13
v_sqrt_f32 v181, v181
v_cvt_pk_bf16_f32 v192, v12, v13
v_cvt_pk_bf16_f32 v194, v180, v181
v_xor_b32 v193, v192, v1
v_xor_b32 v195, v194, v1
s_lshl_b32 s89, s2, 3
s_sub_u32 s90, s3, 0
s_lshl_b32 s90, s90, 1
s_add_u32 s89, s89, s90
s_lshl_b32 s89, s89, 3
s_add_u32 s89, s89, 4096
s_mov_b32 exec_lo, 0
s_mov_b32 exec_hi, 0x80000000
buffer_store_dwordx4 v[192:195], v251, s[40:43], s89 offen sc1
s_mov_b64 exec, -1
LS_prodd:
s_waitcnt vmcnt(0)
s_mov_b32 s89, 0x9E3779B1
v_mul_lo_u32 v1, v2, s89
v_add_u32 v1, 0x7F4A7C15, v1
s_barrier
s_cmp_eq_u32 s3, 7
s_cbranch_scc0 LS_noat
s_mov_b32 s80, s32
s_mov_b32 s81, s33
s_mov_b32 s82, 256
s_mov_b32 s83, 0x00020000
s_and_b32 s90, s2, 3
s_lshl_b32 s90, s90, 6
v_mov_b32 v250, 1
v_mov_b32 v251, 0
s_mov_b64 exec, 1
buffer_atomic_add v250, v251, s[80:83], s90 offen sc1
s_mov_b64 exec, -1
LS_noat:
s_lshr_b32 s44, s95, 4
s_and_b32 s45, s95, 15
s_cmp_eq_u32 s44, 0
s_cselect_b32 s48, s28, s30
s_cselect_b32 s49, s29, s31
s_mov_b32 s50, 1605632
s_mov_b32 s51, 0x00020000
s_lshl_b32 s89, s3, 6
v_add_u32 v16, s89, v0
v_mul_u32_u24 v17, 4682, v16
v_lshrrev_b32 v17, 16, v17
v_mul_u32_u24 v18, 14, v17
v_sub_u32 v18, v16, v18
v_mul_u32_u24 v19, 3584, v17
v_lshlrev_b32 v3, 4, v18
v_add_u32 v19, v19, v3
s_mul_i32 s90, s45, 224
s_cmp_ge_u32 s3, 7
s_cbranch_scc1 LS_skip
buffer_load_dwordx4 v[32:35], v19, s[48:51], s90 offen
s_add_u32 s90, s90, 114688
buffer_load_dwordx4 v[36:39], v19, s[48:51], s90 offen
s_add_u32 s90, s90, 114688
buffer_load_dwordx4 v[40:43], v19, s[48:51], s90 offen
s_add_u32 s90, s90, 114688
buffer_load_dwordx4 v[44:47], v19, s[48:51], s90 offen
s_add_u32 s90, s90, 114688
buffer_load_dwordx4 v[48:51], v19, s[48:51], s90 offen
s_add_u32 s90, s90, 114688
buffer_load_dwordx4 v[52:55], v19, s[48:51], s90 offen
s_add_u32 s90, s90, 114688
buffer_load_dwordx4 v[56:59], v19, s[48:51], s90 offen
s_add_u32 s90, s90, 114688
buffer_load_dwordx4 v[60:63], v19, s[48:51], s90 offen
s_add_u32 s90, s90, 114688
buffer_load_dwordx4 v[64:67], v19, s[48:51], s90 offen
s_add_u32 s90, s90, 114688
buffer_load_dwordx4 v[68:71], v19, s[48:51], s90 offen
s_add_u32 s90, s90, 114688
buffer_load_dwordx4 v[72:75], v19, s[48:51], s90 offen
s_add_u32 s90, s90, 114688
buffer_load_dwordx4 v[76:79], v19, s[48:51], s90 offen
s_add_u32 s90, s90, 114688
buffer_load_dwordx4 v[80:83], v19, s[48:51], s90 offen
s_add_u32 s90, s90, 114688
buffer_load_dwordx4 v[84:87], v19, s[48:51], s90 offen
v_mov_b32 v96, 0
v_mov_b32 v97, 0
v_mov_b32 v98, 0
v_mov_b32 v99, 0
v_mov_b32 v100, 0
v_mov_b32 v101, 0
v_mov_b32 v102, 0
v_mov_b32 v103, 0
s_waitcnt vmcnt(13)
v_lshlrev_b32 v104, 16, v32
v_and_b32 v105, 0xffff0000, v32
v_add_f32 v96, v96, v104
v_add_f32 v97, v97, v105
v_lshlrev_b32 v104, 16, v33
v_and_b32 v105, 0xffff0000, v33
v_add_f32 v98, v98, v104
v_add_f32 v99, v99, v105
v_lshlrev_b32 v104, 16, v34
v_and_b32 v105, 0xffff0000, v34
v_add_f32 v100, v100, v104
v_add_f32 v101, v101, v105
v_lshlrev_b32 v104, 16, v35
v_and_b32 v105, 0xffff0000, v35
v_add_f32 v102, v102, v104
v_add_f32 v103, v103, v105
s_waitcnt vmcnt(12)
v_lshlrev_b32 v104, 16, v36
v_and_b32 v105, 0xffff0000, v36
v_add_f32 v96, v96, v104
v_add_f32 v97, v97, v105
v_lshlrev_b32 v104, 16, v37
v_and_b32 v105, 0xffff0000, v37
v_add_f32 v98, v98, v104
v_add_f32 v99, v99, v105
v_lshlrev_b32 v104, 16, v38
v_and_b32 v105, 0xffff0000, v38
v_add_f32 v100, v100, v104
v_add_f32 v101, v101, v105
v_lshlrev_b32 v104, 16, v39
v_and_b32 v105, 0xffff0000, v39
v_add_f32 v102, v102, v104
v_add_f32 v103, v103, v105
s_waitcnt vmcnt(11)
v_lshlrev_b32 v104, 16, v40
v_and_b32 v105, 0xffff0000, v40
v_add_f32 v96, v96, v104
v_add_f32 v97, v97, v105
v_lshlrev_b32 v104, 16, v41
v_and_b32 v105, 0xffff0000, v41
v_add_f32 v98, v98, v104
v_add_f32 v99, v99, v105
v_lshlrev_b32 v104, 16, v42
v_and_b32 v105, 0xffff0000, v42
v_add_f32 v100, v100, v104
v_add_f32 v101, v101, v105
v_lshlrev_b32 v104, 16, v43
v_and_b32 v105, 0xffff0000, v43
v_add_f32 v102, v102, v104
v_add_f32 v103, v103, v105
s_waitcnt vmcnt(10)
v_lshlrev_b32 v104, 16, v44
v_and_b32 v105, 0xffff0000, v44
v_add_f32 v96, v96, v104
v_add_f32 v97, v97, v105
v_lshlrev_b32 v104, 16, v45
v_and_b32 v105, 0xffff0000, v45
v_add_f32 v98, v98, v104
v_add_f32 v99, v99, v105
v_lshlrev_b32 v104, 16, v46
v_and_b32 v105, 0xffff0000, v46
v_add_f32 v100, v100, v104
v_add_f32 v101, v101, v105
v_lshlrev_b32 v104, 16, v47
v_and_b32 v105, 0xffff0000, v47
v_add_f32 v102, v102, v104
v_add_f32 v103, v103, v105
s_waitcnt vmcnt(9)
v_lshlrev_b32 v104, 16, v48
v_and_b32 v105, 0xffff0000, v48
v_add_f32 v96, v96, v104
v_add_f32 v97, v97, v105
v_lshlrev_b32 v104, 16, v49
v_and_b32 v105, 0xffff0000, v49
v_add_f32 v98, v98, v104
v_add_f32 v99, v99, v105
v_lshlrev_b32 v104, 16, v50
v_and_b32 v105, 0xffff0000, v50
v_add_f32 v100, v100, v104
v_add_f32 v101, v101, v105
v_lshlrev_b32 v104, 16, v51
v_and_b32 v105, 0xffff0000, v51
v_add_f32 v102, v102, v104
v_add_f32 v103, v103, v105
s_waitcnt vmcnt(8)
v_lshlrev_b32 v104, 16, v52
v_and_b32 v105, 0xffff0000, v52
v_add_f32 v96, v96, v104
v_add_f32 v97, v97, v105
v_lshlrev_b32 v104, 16, v53
v_and_b32 v105, 0xffff0000, v53
v_add_f32 v98, v98, v104
v_add_f32 v99, v99, v105
v_lshlrev_b32 v104, 16, v54
v_and_b32 v105, 0xffff0000, v54
v_add_f32 v100, v100, v104
v_add_f32 v101, v101, v105
v_lshlrev_b32 v104, 16, v55
v_and_b32 v105, 0xffff0000, v55
v_add_f32 v102, v102, v104
v_add_f32 v103, v103, v105
s_waitcnt vmcnt(7)
v_lshlrev_b32 v104, 16, v56
v_and_b32 v105, 0xffff0000, v56
v_add_f32 v96, v96, v104
v_add_f32 v97, v97, v105
v_lshlrev_b32 v104, 16, v57
v_and_b32 v105, 0xffff0000, v57
v_add_f32 v98, v98, v104
v_add_f32 v99, v99, v105
v_lshlrev_b32 v104, 16, v58
v_and_b32 v105, 0xffff0000, v58
v_add_f32 v100, v100, v104
v_add_f32 v101, v101, v105
v_lshlrev_b32 v104, 16, v59
v_and_b32 v105, 0xffff0000, v59
v_add_f32 v102, v102, v104
v_add_f32 v103, v103, v105
s_waitcnt vmcnt(6)
v_lshlrev_b32 v104, 16, v60
v_and_b32 v105, 0xffff0000, v60
v_add_f32 v96, v96, v104
v_add_f32 v97, v97, v105
v_lshlrev_b32 v104, 16, v61
v_and_b32 v105, 0xffff0000, v61
v_add_f32 v98, v98, v104
v_add_f32 v99, v99, v105
v_lshlrev_b32 v104, 16, v62
v_and_b32 v105, 0xffff0000, v62
v_add_f32 v100, v100, v104
v_add_f32 v101, v101, v105
v_lshlrev_b32 v104, 16, v63
v_and_b32 v105, 0xffff0000, v63
v_add_f32 v102, v102, v104
v_add_f32 v103, v103, v105
s_waitcnt vmcnt(5)
v_lshlrev_b32 v104, 16, v64
v_and_b32 v105, 0xffff0000, v64
v_add_f32 v96, v96, v104
v_add_f32 v97, v97, v105
v_lshlrev_b32 v104, 16, v65
v_and_b32 v105, 0xffff0000, v65
v_add_f32 v98, v98, v104
v_add_f32 v99, v99, v105
v_lshlrev_b32 v104, 16, v66
v_and_b32 v105, 0xffff0000, v66
v_add_f32 v100, v100, v104
v_add_f32 v101, v101, v105
v_lshlrev_b32 v104, 16, v67
v_and_b32 v105, 0xffff0000, v67
v_add_f32 v102, v102, v104
v_add_f32 v103, v103, v105
s_waitcnt vmcnt(4)
v_lshlrev_b32 v104, 16, v68
v_and_b32 v105, 0xffff0000, v68
v_add_f32 v96, v96, v104
v_add_f32 v97, v97, v105
v_lshlrev_b32 v104, 16, v69
v_and_b32 v105, 0xffff0000, v69
v_add_f32 v98, v98, v104
v_add_f32 v99, v99, v105
v_lshlrev_b32 v104, 16, v70
v_and_b32 v105, 0xffff0000, v70
v_add_f32 v100, v100, v104
v_add_f32 v101, v101, v105
v_lshlrev_b32 v104, 16, v71
v_and_b32 v105, 0xffff0000, v71
v_add_f32 v102, v102, v104
v_add_f32 v103, v103, v105
s_waitcnt vmcnt(3)
v_lshlrev_b32 v104, 16, v72
v_and_b32 v105, 0xffff0000, v72
v_add_f32 v96, v96, v104
v_add_f32 v97, v97, v105
v_lshlrev_b32 v104, 16, v73
v_and_b32 v105, 0xffff0000, v73
v_add_f32 v98, v98, v104
v_add_f32 v99, v99, v105
v_lshlrev_b32 v104, 16, v74
v_and_b32 v105, 0xffff0000, v74
v_add_f32 v100, v100, v104
v_add_f32 v101, v101, v105
v_lshlrev_b32 v104, 16, v75
v_and_b32 v105, 0xffff0000, v75
v_add_f32 v102, v102, v104
v_add_f32 v103, v103, v105
s_waitcnt vmcnt(2)
v_lshlrev_b32 v104, 16, v76
v_and_b32 v105, 0xffff0000, v76
v_add_f32 v96, v96, v104
v_add_f32 v97, v97, v105
v_lshlrev_b32 v104, 16, v77
v_and_b32 v105, 0xffff0000, v77
v_add_f32 v98, v98, v104
v_add_f32 v99, v99, v105
v_lshlrev_b32 v104, 16, v78
v_and_b32 v105, 0xffff0000, v78
v_add_f32 v100, v100, v104
v_add_f32 v101, v101, v105
v_lshlrev_b32 v104, 16, v79
v_and_b32 v105, 0xffff0000, v79
v_add_f32 v102, v102, v104
v_add_f32 v103, v103, v105
s_waitcnt vmcnt(1)
v_lshlrev_b32 v104, 16, v80
v_and_b32 v105, 0xffff0000, v80
v_add_f32 v96, v96, v104
v_add_f32 v97, v97, v105
v_lshlrev_b32 v104, 16, v81
v_and_b32 v105, 0xffff0000, v81
v_add_f32 v98, v98, v104
v_add_f32 v99, v99, v105
v_lshlrev_b32 v104, 16, v82
v_and_b32 v105, 0xffff0000, v82
v_add_f32 v100, v100, v104
v_add_f32 v101, v101, v105
v_lshlrev_b32 v104, 16, v83
v_and_b32 v105, 0xffff0000, v83
v_add_f32 v102, v102, v104
v_add_f32 v103, v103, v105
s_waitcnt vmcnt(0)
v_lshlrev_b32 v104, 16, v84
v_and_b32 v105, 0xffff0000, v84
v_add_f32 v96, v96, v104
v_add_f32 v97, v97, v105
v_lshlrev_b32 v104, 16, v85
v_and_b32 v105, 0xffff0000, v85
v_add_f32 v98, v98, v104
v_add_f32 v99, v99, v105
v_lshlrev_b32 v104, 16, v86
v_and_b32 v105, 0xffff0000, v86
v_add_f32 v100, v100, v104
v_add_f32 v101, v101, v105
v_lshlrev_b32 v104, 16, v87
v_and_b32 v105, 0xffff0000, v87
v_add_f32 v102, v102, v104
v_add_f32 v103, v103, v105
v_mul_u32_u24 v3, 448, v17
v_lshlrev_b32 v4, 5, v18
v_add_u32 v3, v3, v4
ds_write_b128 v3, v[96:99]
ds_write_b128 v3, v[100:103] offset:16
LS_skip:
s_waitcnt lgkmcnt(0)
s_barrier
s_cmp_ge_u32 s3, 2
s_cbranch_scc1 LS_done
v_lshlrev_b32 v3, 2, v16
ds_read_b32 v32, v3 offset:0
ds_read_b32 v33, v3 offset:448
ds_read_b32 v34, v3 offset:896
ds_read_b32 v35, v3 offset:1344
ds_read_b32 v36, v3 offset:1792
ds_read_b32 v37, v3 offset:2240
ds_read_b32 v38, v3 offset:2688
ds_read_b32 v39, v3 offset:3136
ds_read_b32 v40, v3 offset:3584
ds_read_b32 v41, v3 offset:4032
ds_read_b32 v42, v3 offset:4480
ds_read_b32 v43, v3 offset:4928
ds_read_b32 v44, v3 offset:5376
ds_read_b32 v45, v3 offset:5824
ds_read_b32 v46, v3 offset:6272
ds_read_b32 v47, v3 offset:6720
ds_read_b32 v48, v3 offset:7168
ds_read_b32 v49, v3 offset:7616
ds_read_b32 v50, v3 offset:8064
ds_read_b32 v51, v3 offset:8512
ds_read_b32 v52, v3 offset:8960
ds_read_b32 v53, v3 offset:9408
ds_read_b32 v54, v3 offset:9856
ds_read_b32 v55, v3 offset:10304
ds_read_b32 v56, v3 offset:10752
ds_read_b32 v57, v3 offset:11200
ds_read_b32 v58, v3 offset:11648
ds_read_b32 v59, v3 offset:12096
ds_read_b32 v60, v3 offset:12544
ds_read_b32 v61, v3 offset:12992
ds_read_b32 v62, v3 offset:13440
ds_read_b32 v63, v3 offset:13888
s_waitcnt lgkmcnt(0)
v_add_f32 v32, v32, v33
v_add_f32 v32, v32, v34
v_add_f32 v32, v32, v35
v_add_f32 v32, v32, v36
v_add_f32 v32, v32, v37
v_add_f32 v32, v32, v38
v_add_f32 v32, v32, v39
v_add_f32 v32, v32, v40
v_add_f32 v32, v32, v41
v_add_f32 v32, v32, v42
v_add_f32 v32, v32, v43
v_add_f32 v32, v32, v44
v_add_f32 v32, v32, v45
v_add_f32 v32, v32, v46
v_add_f32 v32, v32, v47
v_add_f32 v32, v32, v48
v_add_f32 v32, v32, v49
v_add_f32 v32, v32, v50
v_add_f32 v32, v32, v51
v_add_f32 v32, v32, v52
v_add_f32 v32, v32, v53
v_add_f32 v32, v32, v54
v_add_f32 v32, v32, v55
v_add_f32 v32, v32, v56
v_add_f32 v32, v32, v57
v_add_f32 v32, v32, v58
v_add_f32 v32, v32, v59
v_add_f32 v32, v32, v60
v_add_f32 v32, v32, v61
v_add_f32 v32, v32, v62
v_add_f32 v32, v32, v63
v_cvt_pk_bf16_f32 v33, v32, v32
v_and_b32 v33, 0xffff0000, v33
v_sub_f32 v33, v32, v33
v_cvt_pk_bf16_f32 v68, v32, v33
v_mov_b32 v69, 0
v_mov_b32 v70, 0
v_mov_b32 v71, 0
v_mov_b32 v72, 0
v_mov_b32 v73, 0
v_mov_b32 v74, 0
v_mov_b32 v75, 0
v_lshrrev_b32 v3, 4, v16
s_mul_i32 s90, s45, 7
v_add_u32 v3, s90, v3
v_mul_u32_u24 v3, 29, v3
v_add_u32 v3, 28, v3
v_lshlrev_b32 v3, 10, v3
v_and_b32 v4, 15, v16
s_lshl_b32 s90, s44, 4
v_add_u32 v4, s90, v4
v_lshlrev_b32 v4, 4, v4
v_add_u32 v3, v3, v4
s_mov_b32 s90, 4194304
v_cmp_gt_u32 vcc, 112, v16
s_and_saveexec_b64 s[52:53], vcc
s_cbranch_execz LS_rest
buffer_store_dwordx4 v[68:71], v3, s[40:43], s90 offen sc1
buffer_store_dwordx4 v[72:75], v3, s[40:43], s90 offen offset:512
LS_rest:
s_mov_b64 exec, s[52:53]
LS_done:
s_cmp_eq_u32 s3, 7
s_cbranch_scc0 LS_noe
s_cmp_eq_u32 s95, 0
s_cbranch_scc0 LS_noe
s_mov_b32 s80, s32
s_mov_b32 s81, s33
s_mov_b32 s82, 256
s_mov_b32 s83, 0x00020000
v_and_b32 v250, 3, v0
v_lshlrev_b32 v250, 6, v250
s_mov_b32 s90, 0
LS_epoll:
buffer_load_dword v252, v250, s[80:83], 0 offen sc1
s_waitcnt vmcnt(0)
v_cmp_ne_u32 vcc, 64, v252
s_cbranch_vccz LS_eok
s_add_u32 s90, s90, 1
s_cmp_lt_u32 s90, 0x40000
s_cbranch_scc1 LS_epoll
LS_eok:
s_mov_b64 exec, 1
buffer_store_dword v1, v251, s[40:43], 0 offen sc1
s_mov_b64 exec, -1
LS_noe:
s_endpgm
LA_end:
s_endpgm
.globl ffn_kernel
.p2align 8
.type ffn_kernel,@function
ffn_kernel:
s_cmp_ge_u32 s2, 256
s_cbranch_scc1 LC_end
s_load_dwordx2 s[4:5], s[0:1], 120
s_load_dwordx2 s[6:7], s[0:1], 104
v_lshrrev_b32 v9, 6, v0
v_and_b32 v0, 63, v0
v_readfirstlane_b32 s24, v9
s_and_b32 s25, s2, 7
s_lshr_b32 s26, s2, 3
s_getpc_b64 s[44:45]
LPF_c:
s_sub_u32 s44, s44, LPF_c - ffn_kernel
s_subb_u32 s45, s45, 0
s_mul_i32 s46, s26, 4
s_add_u32 s46, s46, s24
s_lshl_b32 s46, s46, 10
s_cmp_ge_u32 s46, code_end - ffn_kernel
s_cbranch_scc1 LPFX_c
v_lshlrev_b32 v240, 4, v0
v_add_u32 v240, s46, v240
v_min_u32 v240, code_end - ffn_kernel - 16, v240
global_load_dwordx4 v[244:247], v240, s[44:45]
LPFX_c:
s_lshr_b32 s27, s25, 1
s_lshl_b32 s27, s27, 2
s_and_b32 s28, s26, 3
s_add_u32 s27, s27, s28
s_and_b32 s28, s25, 1
s_lshl_b32 s28, s28, 3
s_lshr_b32 s29, s26, 2
s_add_u32 s28, s28, s29
s_lshl_b32 s29, s27, 2
s_add_u32 s29, s29, s24
v_lshlrev_b32 v1, 4, v0
s_mul_i32 s30, s24, 28672
s_mul_i32 s33, s28, 7
s_mul_i32 s32, s33, 29696
s_lshl_b32 s34, s29, 5
s_mul_i32 s35, s29, 28672
s_mul_i32 s36, s24, 7168
s_add_u32 s46, s36, s32
s_waitcnt lgkmcnt(0)
s_add_u32 s12, s4, 4194304
s_addc_u32 s13, s5, 0
s_mov_b32 s14, 3325952
s_mov_b32 s15, 0x00020000
s_add_u32 s8, s4, 65536
s_addc_u32 s9, s5, 0
s_mov_b32 s10, 1835008
s_mov_b32 s11, 0x00020000
s_add_u32 s37, s46, 0
s_add_u32 s38, s36, 114688
s_mov_b32 m0, s38
s_nop 0
buffer_load_dwordx4 v1, s[12:15], s37 offen offset:0 lds
buffer_load_dwordx4 v1, s[12:15], s37 offen offset:1024 lds
buffer_load_dwordx4 v1, s[12:15], s37 offen offset:2048 lds
buffer_load_dwordx4 v1, s[12:15], s37 offen offset:3072 lds
s_add_u32 s38, s38, 4096
s_mov_b32 m0, s38
s_add_u32 s37, s37, 4096
buffer_load_dwordx4 v1, s[12:15], s37 offen offset:0 lds
buffer_load_dwordx4 v1, s[12:15], s37 offen offset:1024 lds
buffer_load_dwordx4 v1, s[12:15], s37 offen offset:2048 lds
s_mov_b32 s39, s24
s_mul_i32 s37, s39, 29696
s_add_u32 s37, s37, s32
s_add_u32 s37, s37, 28672
s_lshl_b32 s38, s39, 10
s_add_u32 s38, s38, 143360
s_mov_b32 m0, s38
s_nop 0
buffer_load_dwordx4 v1, s[12:15], s37 offen lds
s_add_u32 s39, s24, 4
s_min_u32 s39, s39, 6
s_mul_i32 s37, s39, 29696
s_add_u32 s37, s37, s32
s_add_u32 s37, s37, 28672
s_lshl_b32 s38, s39, 10
s_add_u32 s38, s38, 143360
s_mov_b32 m0, s38
s_nop 0
buffer_load_dwordx4 v1, s[12:15], s37 offen lds
s_mov_b32 s47, s30
s_mov_b32 s48, s35
s_mov_b32 m0, s47
s_add_u32 s47, s47, 4096
s_nop 0
buffer_load_dwordx4 v1, s[8:11], s48 offen offset:0 lds
buffer_load_dwordx4 v1, s[8:11], s48 offen offset:1024 lds
buffer_load_dwordx4 v1, s[8:11], s48 offen offset:2048 lds
buffer_load_dwordx4 v1, s[8:11], s48 offen offset:3072 lds
s_mov_b32 m0, s47
s_add_u32 s47, s47, 4096
s_add_u32 s48, s48, 4096
buffer_load_dwordx4 v1, s[8:11], s48 offen offset:0 lds
buffer_load_dwordx4 v1, s[8:11], s48 offen offset:1024 lds
buffer_load_dwordx4 v1, s[8:11], s48 offen offset:2048 lds
buffer_load_dwordx4 v1, s[8:11], s48 offen offset:3072 lds
s_add_u32 s16, s4, 10485760
s_addc_u32 s17, s5, 0
s_mov_b32 s18, 7340032
s_mov_b32 s19, 0x00020000
s_add_u32 s20, s4, 2097152
s_addc_u32 s21, s5, 0
s_mov_b32 s22, 1835008
s_mov_b32 s23, 0x00020000
v_mov_b32 v2, v1
v_add_u32 v3, 0x10000, v1
v_add_u32 v4, 0x20000, v1
v_lshrrev_b32 v9, 5, v0
v_lshlrev_b32 v9, 9, v9
v_bfe_u32 v10, v0, 2, 2
v_lshlrev_b32 v10, 6, v10
v_add_u32 v9, v9, v10
v_bfe_u32 v10, v0, 4, 1
v_lshlrev_b32 v10, 5, v10
v_add_u32 v9, v9, v10
v_and_b32 v10, 3, v0
v_lshlrev_b32 v10, 3, v10
v_add_u32 v9, v9, v10
v_add_u32 v5, s30, v9
s_mul_i32 s31, s29, 112
s_add_u32 s31, s31, s33
s_lshl_b32 s31, s31, 10
v_and_b32 v9, 31, v0
v_add_u32 v9, s34, v9
v_mul_u32_u24 v9, 896, v9
v_lshrrev_b32 v10, 5, v0
v_lshlrev_b32 v10, 4, v10
v_add_u32 v8, v9, v10
s_mov_b32 s50, 0x00020001
s_mov_b32 s51, 0x00020001
v_mov_b32 v216, 0
v_mov_b32 v9, 0x3f803f80
v_cndmask_b32 v216, v216, v9, s[50:51]
v_mov_b32 v217, v216
v_mov_b32 v218, v216
v_mov_b32 v219, v216
s_mov_b32 s52, 0xaaaaaaaa
s_mov_b32 s53, 0xaaaaaaaa
s_mov_b32 s54, 0xcccccccc
s_mov_b32 s55, 0xcccccccc
s_mov_b32 s56, 0xff00ff00
s_mov_b32 s57, 0xff00ff00
s_mov_b32 s58, 0xffff0000
s_mov_b32 s59, 0xffff0000
s_mov_b32 s72, 0xf0f0f0f0
s_mov_b32 s73, 0xf0f0f0f0
s_add_u32 s76, s4, 8388608
s_addc_u32 s77, s5, 0
s_mov_b32 s78, 1605632
s_mov_b32 s79, 0x00020000
s_min_u32 s45, s26, 27
s_and_b32 s44, s45, 3
s_lshl_b32 s94, s25, 2
s_add_u32 s44, s44, s94
s_lshr_b32 s45, s45, 2
s_mul_i32 s94, s24, 28
s_mul_i32 s92, s45, 224
s_add_u32 s92, s92, s94
s_lshl_b32 s92, s92, 10
v_add_u32 v224, s92, v1
s_add_u32 s92, s92, 114688
v_add_u32 v225, s92, v1
s_mul_i32 s92, s44, 224
s_add_u32 s92, s92, s94
s_lshl_b32 s92, s92, 10
v_add_u32 v226, s92, v1
s_add_u32 s92, s92, 114688
v_add_u32 v227, s92, v1
s_mul_i32 s93, s45, 0
s_mov_b32 s94, s93
s_waitcnt vmcnt(8)
s_barrier
s_waitcnt vmcnt(7)
ds_read_b64_tr_b16 v[80:81], v5 offset:0
ds_read_b64_tr_b16 v[82:83], v5 offset:256
ds_read_b128 v[48:51], v3 offset:49152
s_mov_b32 m0, s47
s_add_u32 s47, s47, 4096
s_add_u32 s48, s48, 4096
buffer_load_dwordx4 v1, s[8:11], s48 offen offset:0 lds
s_waitcnt vmcnt(7)
ds_read_b64_tr_b16 v[84:85], v5 offset:1024
ds_read_b64_tr_b16 v[86:87], v5 offset:1280
ds_read_b128 v[52:55], v3 offset:50176
buffer_load_dwordx4 v1, s[8:11], s48 offen offset:1024 lds
s_waitcnt lgkmcnt(3)
v_mfma_f32_32x32x16_bf16 v[16:31], v[48:51], v[80:83], 0
s_waitcnt vmcnt(7)
ds_read_b64_tr_b16 v[88:89], v5 offset:2048
ds_read_b64_tr_b16 v[90:91], v5 offset:2304
v_mfma_f32_32x32x16_bf16 v[32:47], v[80:83], v[80:83], 0
ds_read_b128 v[56:59], v3 offset:51200
buffer_load_dwordx4 v1, s[8:11], s48 offen offset:2048 lds
v_mfma_f32_16x16x32_bf16 v[220:223], v[216:219], v[80:83], 0
s_waitcnt lgkmcnt(3)
v_mfma_f32_32x32x16_bf16 v[16:31], v[52:55], v[84:87], v[16:31]
s_waitcnt vmcnt(7)
ds_read_b64_tr_b16 v[92:93], v5 offset:3072
ds_read_b64_tr_b16 v[94:95], v5 offset:3328
v_mfma_f32_32x32x16_bf16 v[32:47], v[84:87], v[84:87], v[32:47]
ds_read_b128 v[60:63], v3 offset:52224
buffer_load_dwordx4 v1, s[8:11], s48 offen offset:3072 lds
v_mfma_f32_16x16x32_bf16 v[220:223], v[216:219], v[84:87], v[220:223]
s_waitcnt lgkmcnt(3)
v_mfma_f32_32x32x16_bf16 v[16:31], v[56:59], v[88:91], v[16:31]
s_waitcnt vmcnt(7)
ds_read_b64_tr_b16 v[96:97], v5 offset:4096
ds_read_b64_tr_b16 v[98:99], v5 offset:4352
v_mfma_f32_32x32x16_bf16 v[32:47], v[88:91], v[88:91], v[32:47]
ds_read_b128 v[64:67], v3 offset:53248
s_mov_b32 m0, s47
s_add_u32 s47, s47, 4096
s_add_u32 s48, s48, 4096
buffer_load_dwordx4 v1, s[8:11], s48 offen offset:0 lds
v_mfma_f32_16x16x32_bf16 v[220:223], v[216:219], v[88:91], v[220:223]
s_waitcnt lgkmcnt(3)
v_mfma_f32_32x32x16_bf16 v[16:31], v[60:63], v[92:95], v[16:31]
s_waitcnt vmcnt(7)
ds_read_b64_tr_b16 v[100:101], v5 offset:5120
ds_read_b64_tr_b16 v[102:103], v5 offset:5376
v_mfma_f32_32x32x16_bf16 v[32:47], v[92:95], v[92:95], v[32:47]
ds_read_b128 v[68:71], v3 offset:54272
buffer_load_dwordx4 v1, s[8:11], s48 offen offset:1024 lds
v_mfma_f32_16x16x32_bf16 v[220:223], v[216:219], v[92:95], v[220:223]
s_waitcnt lgkmcnt(3)
v_mfma_f32_32x32x16_bf16 v[16:31], v[64:67], v[96:99], v[16:31]
s_waitcnt vmcnt(7)
ds_read_b64_tr_b16 v[104:105], v5 offset:6144
ds_read_b64_tr_b16 v[106:107], v5 offset:6400
v_mfma_f32_32x32x16_bf16 v[32:47], v[96:99], v[96:99], v[32:47]
ds_read_b128 v[72:75], v3 offset:55296
buffer_load_dwordx4 v1, s[8:11], s48 offen offset:2048 lds
v_mfma_f32_16x16x32_bf16 v[220:223], v[216:219], v[96:99], v[220:223]
s_waitcnt lgkmcnt(3)
v_mfma_f32_32x32x16_bf16 v[16:31], v[68:71], v[100:103], v[16:31]
s_waitcnt vmcnt(7)
ds_read_b64_tr_b16 v[108:109], v5 offset:7168
ds_read_b64_tr_b16 v[110:111], v5 offset:7424
v_mfma_f32_32x32x16_bf16 v[32:47], v[100:103], v[100:103], v[32:47]
ds_read_b128 v[76:79], v3 offset:56320
buffer_load_dwordx4 v1, s[8:11], s48 offen offset:3072 lds
v_mfma_f32_16x16x32_bf16 v[220:223], v[216:219], v[100:103], v[220:223]
s_waitcnt lgkmcnt(3)
v_mfma_f32_32x32x16_bf16 v[16:31], v[72:75], v[104:107], v[16:31]
s_waitcnt vmcnt(7)
ds_read_b64_tr_b16 v[112:113], v5 offset:8192
ds_read_b64_tr_b16 v[114:115], v5 offset:8448
v_mfma_f32_32x32x16_bf16 v[32:47], v[104:107], v[104:107], v[32:47]
ds_read_b128 v[48:51], v3 offset:57344
s_mov_b32 m0, s47
s_add_u32 s47, s47, 4096
s_add_u32 s48, s48, 4096
buffer_load_dwordx4 v1, s[8:11], s48 offen offset:0 lds
v_mfma_f32_16x16x32_bf16 v[220:223], v[216:219], v[104:107], v[220:223]
s_waitcnt lgkmcnt(3)
v_mfma_f32_32x32x16_bf16 v[16:31], v[76:79], v[108:111], v[16:31]
s_waitcnt vmcnt(7)
ds_read_b64_tr_b16 v[116:117], v5 offset:9216
ds_read_b64_tr_b16 v[118:119], v5 offset:9472
v_mfma_f32_32x32x16_bf16 v[32:47], v[108:111], v[108:111], v[32:47]
ds_read_b128 v[52:55], v3 offset:58368
buffer_load_dwordx4 v1, s[8:11], s48 offen offset:1024 lds
v_mfma_f32_16x16x32_bf16 v[220:223], v[216:219], v[108:111], v[220:223]
s_waitcnt lgkmcnt(3)
v_mfma_f32_32x32x16_bf16 v[16:31], v[48:51], v[112:115], v[16:31]
s_waitcnt vmcnt(7)
ds_read_b64_tr_b16 v[120:121], v5 offset:10240
ds_read_b64_tr_b16 v[122:123], v5 offset:10496
v_mfma_f32_32x32x16_bf16 v[32:47], v[112:115], v[112:115], v[32:47]
ds_read_b128 v[56:59], v3 offset:59392
buffer_load_dwordx4 v1, s[8:11], s48 offen offset:2048 lds
v_mfma_f32_16x16x32_bf16 v[220:223], v[216:219], v[112:115], v[220:223]
s_waitcnt lgkmcnt(3)
v_mfma_f32_32x32x16_bf16 v[16:31], v[52:55], v[116:119], v[16:31]
s_waitcnt vmcnt(7)
ds_read_b64_tr_b16 v[124:125], v5 offset:11264
ds_read_b64_tr_b16 v[126:127], v5 offset:11520
v_mfma_f32_32x32x16_bf16 v[32:47], v[116:119], v[116:119], v[32:47]
ds_read_b128 v[60:63], v3 offset:60416
buffer_load_dwordx4 v1, s[8:11], s48 offen offset:3072 lds
v_mfma_f32_16x16x32_bf16 v[220:223], v[216:219], v[116:119], v[220:223]
s_waitcnt lgkmcnt(3)
v_mfma_f32_32x32x16_bf16 v[16:31], v[56:59], v[120:123], v[16:31]
s_waitcnt vmcnt(7)
ds_read_b64_tr_b16 v[128:129], v5 offset:12288
ds_read_b64_tr_b16 v[130:131], v5 offset:12544
v_mfma_f32_32x32x16_bf16 v[32:47], v[120:123], v[120:123], v[32:47]
ds_read_b128 v[64:67], v3 offset:61440
s_mov_b32 m0, s47
s_add_u32 s47, s47, 4096
s_add_u32 s48, s48, 4096
buffer_load_dwordx4 v1, s[8:11], s48 offen offset:0 lds
v_mfma_f32_16x16x32_bf16 v[220:223], v[216:219], v[120:123], v[220:223]
s_waitcnt lgkmcnt(3)
v_mfma_f32_32x32x16_bf16 v[16:31], v[60:63], v[124:127], v[16:31]
s_waitcnt vmcnt(7)
ds_read_b64_tr_b16 v[132:133], v5 offset:13312
ds_read_b64_tr_b16 v[134:135], v5 offset:13568
v_mfma_f32_32x32x16_bf16 v[32:47], v[124:127], v[124:127], v[32:47]
ds_read_b128 v[68:71], v3 offset:62464
buffer_load_dwordx4 v1, s[8:11], s48 offen offset:1024 lds
v_mfma_f32_16x16x32_bf16 v[220:223], v[216:219], v[124:127], v[220:223]
s_waitcnt lgkmcnt(3)
v_mfma_f32_32x32x16_bf16 v[16:31], v[64:67], v[128:131], v[16:31]
s_waitcnt vmcnt(7)
ds_read_b64_tr_b16 v[136:137], v5 offset:14336
ds_read_b64_tr_b16 v[138:139], v5 offset:14592
v_mfma_f32_32x32x16_bf16 v[32:47], v[128:131], v[128:131], v[32:47]
ds_read_b128 v[72:75], v3 offset:63488
buffer_load_dwordx4 v1, s[8:11], s48 offen offset:2048 lds
v_mfma_f32_16x16x32_bf16 v[220:223], v[216:219], v[128:131], v[220:223]
s_waitcnt lgkmcnt(3)
v_mfma_f32_32x32x16_bf16 v[16:31], v[68:71], v[132:135], v[16:31]
s_waitcnt vmcnt(7)
ds_read_b64_tr_b16 v[140:141], v5 offset:15360
ds_read_b64_tr_b16 v[142:143], v5 offset:15616
v_mfma_f32_32x32x16_bf16 v[32:47], v[132:135], v[132:135], v[32:47]
ds_read_b128 v[76:79], v3 offset:64512
buffer_load_dwordx4 v1, s[8:11], s48 offen offset:3072 lds
v_mfma_f32_16x16x32_bf16 v[220:223], v[216:219], v[132:135], v[220:223]
s_waitcnt lgkmcnt(3)
v_mfma_f32_32x32x16_bf16 v[16:31], v[72:75], v[136:139], v[16:31]
s_waitcnt vmcnt(7)
ds_read_b64_tr_b16 v[144:145], v5 offset:16384
ds_read_b64_tr_b16 v[146:147], v5 offset:16640
v_mfma_f32_32x32x16_bf16 v[32:47], v[136:139], v[136:139], v[32:47]
ds_read_b128 v[48:51], v4 offset:0
s_mov_b32 m0, s47
s_add_u32 s47, s47, 4096
s_add_u32 s48, s48, 4096
buffer_load_dwordx4 v1, s[8:11], s48 offen offset:0 lds
v_mfma_f32_16x16x32_bf16 v[220:223], v[216:219], v[136:139], v[220:223]
s_waitcnt lgkmcnt(3)
v_mfma_f32_32x32x16_bf16 v[16:31], v[76:79], v[140:143], v[16:31]
s_waitcnt vmcnt(7)
ds_read_b64_tr_b16 v[148:149], v5 offset:17408
ds_read_b64_tr_b16 v[150:151], v5 offset:17664
v_mfma_f32_32x32x16_bf16 v[32:47], v[140:143], v[140:143], v[32:47]
ds_read_b128 v[52:55], v4 offset:1024
buffer_load_dwordx4 v1, s[8:11], s48 offen offset:1024 lds
v_mfma_f32_16x16x32_bf16 v[220:223], v[216:219], v[140:143], v[220:223]
s_waitcnt lgkmcnt(3)
v_mfma_f32_32x32x16_bf16 v[16:31], v[48:51], v[144:147], v[16:31]
s_waitcnt vmcnt(7)
ds_read_b64_tr_b16 v[152:153], v5 offset:18432
ds_read_b64_tr_b16 v[154:155], v5 offset:18688
v_mfma_f32_32x32x16_bf16 v[32:47], v[144:147], v[144:147], v[32:47]
ds_read_b128 v[56:59], v4 offset:2048
buffer_load_dwordx4 v1, s[8:11], s48 offen offset:2048 lds
v_mfma_f32_16x16x32_bf16 v[220:223], v[216:219], v[144:147], v[220:223]
s_waitcnt lgkmcnt(3)
v_mfma_f32_32x32x16_bf16 v[16:31], v[52:55], v[148:151], v[16:31]
s_waitcnt vmcnt(7)
ds_read_b64_tr_b16 v[156:157], v5 offset:19456
ds_read_b64_tr_b16 v[158:159], v5 offset:19712
v_mfma_f32_32x32x16_bf16 v[32:47], v[148:151], v[148:151], v[32:47]
ds_read_b128 v[60:63], v4 offset:3072
buffer_load_dwordx4 v1, s[8:11], s48 offen offset:3072 lds
v_mfma_f32_16x16x32_bf16 v[220:223], v[216:219], v[148:151], v[220:223]
s_waitcnt lgkmcnt(3)
v_mfma_f32_32x32x16_bf16 v[16:31], v[56:59], v[152:155], v[16:31]
s_waitcnt vmcnt(7)
ds_read_b64_tr_b16 v[160:161], v5 offset:20480
ds_read_b64_tr_b16 v[162:163], v5 offset:20736
v_mfma_f32_32x32x16_bf16 v[32:47], v[152:155], v[152:155], v[32:47]
ds_read_b128 v[64:67], v4 offset:4096
v_mfma_f32_16x16x32_bf16 v[220:223], v[216:219], v[152:155], v[220:223]
s_add_u32 s37, s46, 29696
s_add_u32 s38, s30, 0
s_mov_b32 m0, s38
s_nop 0
buffer_load_dwordx4 v1, s[12:15], s37 offen offset:0 lds
s_waitcnt lgkmcnt(3)
v_mfma_f32_32x32x16_bf16 v[16:31], v[60:63], v[156:159], v[16:31]
s_waitcnt vmcnt(7)
ds_read_b64_tr_b16 v[164:165], v5 offset:21504
ds_read_b64_tr_b16 v[166:167], v5 offset:21760
v_mfma_f32_32x32x16_bf16 v[32:47], v[156:159], v[156:159], v[32:47]
ds_read_b128 v[68:71], v4 offset:5120
v_mfma_f32_16x16x32_bf16 v[220:223], v[216:219], v[156:159], v[220:223]
buffer_load_dwordx4 v1, s[12:15], s37 offen offset:1024 lds
s_waitcnt lgkmcnt(3)
v_mfma_f32_32x32x16_bf16 v[16:31], v[64:67], v[160:163], v[16:31]
s_waitcnt vmcnt(7)
ds_read_b64_tr_b16 v[168:169], v5 offset:22528
ds_read_b64_tr_b16 v[170:171], v5 offset:22784
v_mfma_f32_32x32x16_bf16 v[32:47], v[160:163], v[160:163], v[32:47]
ds_read_b128 v[72:75], v4 offset:6144
v_mfma_f32_16x16x32_bf16 v[220:223], v[216:219], v[160:163], v[220:223]
buffer_load_dwordx4 v1, s[12:15], s37 offen offset:2048 lds
s_waitcnt lgkmcnt(3)
v_mfma_f32_32x32x16_bf16 v[16:31], v[68:71], v[164:167], v[16:31]
s_waitcnt vmcnt(7)
ds_read_b64_tr_b16 v[172:173], v5 offset:23552
ds_read_b64_tr_b16 v[174:175], v5 offset:23808
v_mfma_f32_32x32x16_bf16 v[32:47], v[164:167], v[164:167], v[32:47]
ds_read_b128 v[76:79], v4 offset:7168
v_mfma_f32_16x16x32_bf16 v[220:223], v[216:219], v[164:167], v[220:223]
buffer_load_dwordx4 v1, s[12:15], s37 offen offset:3072 lds
s_waitcnt lgkmcnt(3)
v_mfma_f32_32x32x16_bf16 v[16:31], v[72:75], v[168:171], v[16:31]
s_waitcnt vmcnt(7)
ds_read_b64_tr_b16 v[176:177], v5 offset:24576
ds_read_b64_tr_b16 v[178:179], v5 offset:24832
v_mfma_f32_32x32x16_bf16 v[32:47], v[168:171], v[168:171], v[32:47]
ds_read_b128 v[48:51], v4 offset:8192
v_mfma_f32_16x16x32_bf16 v[220:223], v[216:219], v[168:171], v[220:223]
s_add_u32 s38, s38, 4096
s_mov_b32 m0, s38
s_add_u32 s37, s37, 4096
buffer_load_dwordx4 v1, s[12:15], s37 offen offset:0 lds
s_waitcnt lgkmcnt(3)
v_mfma_f32_32x32x16_bf16 v[16:31], v[76:79], v[172:175], v[16:31]
s_waitcnt vmcnt(7)
ds_read_b64_tr_b16 v[180:181], v5 offset:25600
ds_read_b64_tr_b16 v[182:183], v5 offset:25856
v_mfma_f32_32x32x16_bf16 v[32:47], v[172:175], v[172:175], v[32:47]
ds_read_b128 v[52:55], v4 offset:9216
v_mfma_f32_16x16x32_bf16 v[220:223], v[216:219], v[172:175], v[220:223]
buffer_load_dwordx4 v1, s[12:15], s37 offen offset:1024 lds
s_waitcnt lgkmcnt(3)
v_mfma_f32_32x32x16_bf16 v[16:31], v[48:51], v[176:179], v[16:31]
s_waitcnt vmcnt(7)
ds_read_b64_tr_b16 v[184:185], v5 offset:26624
ds_read_b64_tr_b16 v[186:187], v5 offset:26880
v_mfma_f32_32x32x16_bf16 v[32:47], v[176:179], v[176:179], v[32:47]
ds_read_b128 v[56:59], v4 offset:10240
v_mfma_f32_16x16x32_bf16 v[220:223], v[216:219], v[176:179], v[220:223]
buffer_load_dwordx4 v1, s[12:15], s37 offen offset:2048 lds
s_waitcnt lgkmcnt(3)
v_mfma_f32_32x32x16_bf16 v[16:31], v[52:55], v[180:183], v[16:31]
s_waitcnt vmcnt(7)
ds_read_b64_tr_b16 v[188:189], v5 offset:27648
ds_read_b64_tr_b16 v[190:191], v5 offset:27904
v_mfma_f32_32x32x16_bf16 v[32:47], v[180:183], v[180:183], v[32:47]
ds_read_b128 v[60:63], v4 offset:11264
v_mfma_f32_16x16x32_bf16 v[220:223], v[216:219], v[180:183], v[220:223]
s_add_u32 s37, s46, 59392
s_add_u32 s38, s30, 7168
s_mov_b32 m0, s38
s_nop 0
buffer_load_dwordx4 v1, s[12:15], s37 offen offset:0 lds
s_waitcnt lgkmcnt(3)
v_mfma_f32_32x32x16_bf16 v[16:31], v[56:59], v[184:187], v[16:31]
v_mfma_f32_32x32x16_bf16 v[32:47], v[184:187], v[184:187], v[32:47]
ds_read_b128 v[64:67], v4 offset:12288
v_mfma_f32_16x16x32_bf16 v[220:223], v[216:219], v[184:187], v[220:223]
buffer_load_dwordx4 v1, s[12:15], s37 offen offset:1024 lds
s_waitcnt lgkmcnt(0)
v_mfma_f32_32x32x16_bf16 v[16:31], v[60:63], v[188:191], v[16:31]
v_mfma_f32_32x32x16_bf16 v[32:47], v[188:191], v[188:191], v[32:47]
v_mfma_f32_16x16x32_bf16 v[220:223], v[216:219], v[188:191], v[220:223]
buffer_load_dwordx4 v1, s[12:15], s37 offen offset:2048 lds
buffer_load_dwordx4 v1, s[12:15], s37 offen offset:3072 lds
s_add_u32 s38, s38, 4096
s_mov_b32 m0, s38
s_add_u32 s37, s37, 4096
buffer_load_dwordx4 v1, s[12:15], s37 offen offset:0 lds
buffer_load_dwordx4 v1, s[12:15], s37 offen offset:1024 lds
buffer_load_dwordx4 v1, s[12:15], s37 offen offset:2048 lds
s_mov_b32 s84, s4
s_mov_b32 s85, s5
s_mov_b32 s86, 65536
s_mov_b32 s87, 0x00020000
s_lshl_b32 s43, s27, 4
s_add_u32 s43, s43, s28
s_lshl_b32 s43, s43, 6
s_add_u32 s43, s43, 24576
v_mov_b32 v246, 0
s_mov_b64 exec, 1
buffer_load_dword v247, v246, s[84:87], s43 offen sc1
s_mov_b64 exec, -1
s_min_u32 s41, s28, 13
s_cmp_ge_u32 s41, 7
s_cbranch_scc1 LC_hn_p1
s_cmp_ge_u32 s41, 3
s_cbranch_scc1 LC_hn_p01
s_cmp_ge_u32 s41, 1
s_cbranch_scc1 LC_hn_p001
buffer_store_dwordx4 v[80:83], v8, s[20:23], 0 offen offset:0 sc1
buffer_store_dwordx4 v[84:87], v8, s[20:23], 0 offen offset:32 sc1
s_branch LC_hn_done
LC_hn_p001:
s_cmp_ge_u32 s41, 2
s_cbranch_scc1 LC_hn_p0011
buffer_store_dwordx4 v[88:91], v8, s[20:23], 0 offen offset:64 sc1
buffer_store_dwordx4 v[92:95], v8, s[20:23], 0 offen offset:96 sc1
s_branch LC_hn_done
LC_hn_p0011:
buffer_store_dwordx4 v[96:99], v8, s[20:23], 0 offen offset:128 sc1
buffer_store_dwordx4 v[100:103], v8, s[20:23], 0 offen offset:160 sc1
s_branch LC_hn_done
LC_hn_p01:
s_cmp_ge_u32 s41, 5
s_cbranch_scc1 LC_hn_p011
s_cmp_ge_u32 s41, 4
s_cbranch_scc1 LC_hn_p0101
buffer_store_dwordx4 v[104:107], v8, s[20:23], 0 offen offset:192 sc1
buffer_store_dwordx4 v[108:111], v8, s[20:23], 0 offen offset:224 sc1
s_branch LC_hn_done
LC_hn_p0101:
buffer_store_dwordx4 v[112:115], v8, s[20:23], 0 offen offset:256 sc1
buffer_store_dwordx4 v[116:119], v8, s[20:23], 0 offen offset:288 sc1
s_branch LC_hn_done
LC_hn_p011:
s_cmp_ge_u32 s41, 6
s_cbranch_scc1 LC_hn_p0111
buffer_store_dwordx4 v[120:123], v8, s[20:23], 0 offen offset:320 sc1
buffer_store_dwordx4 v[124:127], v8, s[20:23], 0 offen offset:352 sc1
s_branch LC_hn_done
LC_hn_p0111:
buffer_store_dwordx4 v[128:131], v8, s[20:23], 0 offen offset:384 sc1
buffer_store_dwordx4 v[132:135], v8, s[20:23], 0 offen offset:416 sc1
s_branch LC_hn_done
LC_hn_p1:
s_cmp_ge_u32 s41, 10
s_cbranch_scc1 LC_hn_p11
s_cmp_ge_u32 s41, 8
s_cbranch_scc1 LC_hn_p101
buffer_store_dwordx4 v[136:139], v8, s[20:23], 0 offen offset:448 sc1
buffer_store_dwordx4 v[140:143], v8, s[20:23], 0 offen offset:480 sc1
s_branch LC_hn_done
LC_hn_p101:
s_cmp_ge_u32 s41, 9
s_cbranch_scc1 LC_hn_p1011
buffer_store_dwordx4 v[144:147], v8, s[20:23], 0 offen offset:512 sc1
buffer_store_dwordx4 v[148:151], v8, s[20:23], 0 offen offset:544 sc1
s_branch LC_hn_done
LC_hn_p1011:
buffer_store_dwordx4 v[152:155], v8, s[20:23], 0 offen offset:576 sc1
buffer_store_dwordx4 v[156:159], v8, s[20:23], 0 offen offset:608 sc1
s_branch LC_hn_done
LC_hn_p11:
s_cmp_ge_u32 s41, 12
s_cbranch_scc1 LC_hn_p111
s_cmp_ge_u32 s41, 11
s_cbranch_scc1 LC_hn_p1101
buffer_store_dwordx4 v[160:163], v8, s[20:23], 0 offen offset:640 sc1
buffer_store_dwordx4 v[164:167], v8, s[20:23], 0 offen offset:672 sc1
s_branch LC_hn_done
LC_hn_p1101:
buffer_store_dwordx4 v[168:171], v8, s[20:23], 0 offen offset:704 sc1
buffer_store_dwordx4 v[172:175], v8, s[20:23], 0 offen offset:736 sc1
s_branch LC_hn_done
LC_hn_p111:
s_cmp_ge_u32 s41, 13
s_cbranch_scc1 LC_hn_p1111
buffer_store_dwordx4 v[176:179], v8, s[20:23], 0 offen offset:768 sc1
buffer_store_dwordx4 v[180:183], v8, s[20:23], 0 offen offset:800 sc1
s_branch LC_hn_done
LC_hn_p1111:
buffer_store_dwordx4 v[184:187], v8, s[20:23], 0 offen offset:832 sc1
buffer_store_dwordx4 v[188:191], v8, s[20:23], 0 offen offset:864 sc1
s_branch LC_hn_done
LC_hn_done:
s_nop 7
v_cndmask_b32 v192, v32, v33, s[52:53]
v_cndmask_b32 v193, v34, v35, s[52:53]
v_cndmask_b32 v194, v36, v37, s[52:53]
v_cndmask_b32 v195, v38, v39, s[52:53]
v_cndmask_b32 v196, v40, v41, s[52:53]
v_cndmask_b32 v197, v42, v43, s[52:53]
v_cndmask_b32 v198, v44, v45, s[52:53]
v_cndmask_b32 v199, v46, v47, s[52:53]
v_cndmask_b32 v192, v192, v193, s[54:55]
v_cndmask_b32 v193, v194, v195, s[54:55]
v_cndmask_b32 v194, v196, v197, s[54:55]
v_cndmask_b32 v195, v198, v199, s[54:55]
v_cndmask_b32 v192, v192, v193, s[56:57]
v_cndmask_b32 v193, v194, v195, s[56:57]
v_cndmask_b32 v205, v192, v193, s[58:59]
v_mov_b32 v210, v205
v_mov_b32 v211, v220
v_mov_b32 v204, v221
s_nop 0
v_permlane32_swap_b32 v205, v210
v_permlane16_swap_b32 v211, v204
s_nop 1
v_cndmask_b32 v205, v205, v210, s[72:73]
v_mov_b32 v204, v211
s_nop 1
v_permlane32_swap_b32 v204, v211
s_nop 1
s_mov_b32 s40, 0x3b124925
v_mul_f32 v204, s40, v204
v_mul_f32 v205, s40, v205
v_fma_f32 v205, -v204, v204, v205
v_max_f32 v205, 0, v205
v_cvt_pk_bf16_f32 v210, v204, v205
v_and_b32 v211, 0xffff0000, v210
v_add_f32 v211, 0x3727c5ac, v211
v_cvt_pk_bf16_f32 v211, v211, v211
v_and_b32 v211, 0xffff0000, v211
v_sqrt_f32 v211, v211
s_nop 0
v_cvt_pk_bf16_f32 v211, v211, v211
v_and_b32 v208, 0xffff0000, v211
v_rcp_f32 v206, v208
v_and_b32 v210, 0xffff, v210
v_xor_b32 v210, 0x8000, v210
v_mul_f32 v206, 0xbfb8aa3b, v206
v_mov_b32 v213, 0
v_mov_b32 v214, 0
v_mov_b32 v215, 0
v_lshl_or_b32 v212, v210, 16, v210
s_nop 0
s_waitcnt lgkmcnt(0)
v_mfma_f32_32x32x16_bf16 v[16:31], v[64:67], v[212:215], v[16:31]
s_waitcnt vmcnt(10)
s_barrier
ds_read_b128 v[68:71], v2 offset:0
ds_read_b128 v[72:75], v2 offset:1024
ds_read_b128 v[76:79], v2 offset:2048
ds_read_b128 v[48:51], v2 offset:3072
ds_read_b128 v[52:55], v2 offset:4096
ds_read_b128 v[56:59], v2 offset:5120
ds_read_b128 v[60:63], v2 offset:6144
ds_read_b128 v[64:67], v2 offset:28672
s_waitcnt lgkmcnt(4)
v_mfma_f32_32x32x16_bf16 v[32:47], v[68:71], v[80:83], 0
s_add_u32 s37, s46, 89088
s_add_u32 s38, s30, 14336
s_mov_b32 m0, s38
s_nop 0
buffer_load_dwordx4 v1, s[12:15], s37 offen offset:0 lds
ds_read_b128 v[68:71], v2 offset:29696
v_mfma_f32_32x32x16_bf16 v[32:47], v[72:75], v[84:87], v[32:47]
buffer_load_dwordx4 v1, s[12:15], s37 offen offset:1024 lds
ds_read_b128 v[72:75], v2 offset:30720
v_mfma_f32_32x32x16_bf16 v[32:47], v[76:79], v[88:91], v[32:47]
ds_read_b128 v[76:79], v2 offset:31744
v_mfma_f32_32x32x16_bf16 v[32:47], v[48:51], v[92:95], v[32:47]
buffer_load_dwordx4 v1, s[12:15], s37 offen offset:2048 lds
ds_read_b128 v[48:51], v2 offset:32768
s_waitcnt lgkmcnt(4)
v_mfma_f32_32x32x16_bf16 v[32:47], v[52:55], v[96:99], v[32:47]
buffer_load_dwordx4 v1, s[12:15], s37 offen offset:3072 lds
ds_read_b128 v[52:55], v2 offset:33792
v_mfma_f32_32x32x16_bf16 v[32:47], v[56:59], v[100:103], v[32:47]
v_mul_f32 v192, v16, v206
v_mul_f32 v193, v17, v206
v_mul_f32 v194, v18, v206
ds_read_b128 v[56:59], v2 offset:34816
v_mfma_f32_32x32x16_bf16 v[32:47], v[60:63], v[104:107], v[32:47]
v_exp_f32 v192, v192
v_mul_f32 v195, v19, v206
ds_read_b128 v[60:63], v2 offset:57344
v_mfma_f32_32x32x16_bf16 v[32:47], v[64:67], v[108:111], v[32:47]
s_mov_b32 s93, 0
buffer_load_dwordx4 a[0:3], v224, s[76:79], s93 offen offset:0
buffer_load_dwordx4 a[4:7], v225, s[76:79], s93 offen offset:0
v_exp_f32 v193, v193
v_mul_f32 v196, v20, v206
ds_read_b128 v[64:67], v2 offset:58368
s_waitcnt lgkmcnt(4)
v_mfma_f32_32x32x16_bf16 v[32:47], v[68:71], v[112:115], v[32:47]
v_exp_f32 v194, v194
v_mul_f32 v197, v21, v206
ds_read_b128 v[68:71], v2 offset:59392
v_mfma_f32_32x32x16_bf16 v[32:47], v[72:75], v[116:119], v[32:47]
s_add_u32 s38, s38, 4096
s_mov_b32 m0, s38
s_add_u32 s37, s37, 4096
buffer_load_dwordx4 v1, s[12:15], s37 offen offset:0 lds
ds_read_b128 v[72:75], v2 offset:60416
v_mfma_f32_32x32x16_bf16 v[32:47], v[76:79], v[120:123], v[32:47]
v_exp_f32 v195, v195
v_mul_f32 v198, v22, v206
ds_read_b128 v[76:79], v2 offset:61440
v_mfma_f32_32x32x16_bf16 v[32:47], v[48:51], v[124:127], v[32:47]
v_exp_f32 v196, v196
v_mul_f32 v199, v23, v206
ds_read_b128 v[48:51], v2 offset:62464
s_waitcnt lgkmcnt(4)
v_mfma_f32_32x32x16_bf16 v[32:47], v[52:55], v[128:131], v[32:47]
v_exp_f32 v197, v197
v_fma_f32 v192, v192, v208, v208
ds_read_b128 v[52:55], v2 offset:63488
v_mfma_f32_32x32x16_bf16 v[32:47], v[56:59], v[132:135], v[32:47]
v_exp_f32 v198, v198
v_fma_f32 v193, v193, v208, v208
ds_read_b128 v[56:59], v3 offset:20480
v_mfma_f32_32x32x16_bf16 v[32:47], v[60:63], v[136:139], v[32:47]
buffer_load_dwordx4 v1, s[12:15], s37 offen offset:1024 lds
ds_read_b128 v[60:63], v3 offset:21504
v_mfma_f32_32x32x16_bf16 v[32:47], v[64:67], v[140:143], v[32:47]
buffer_load_dwordx4 a[8:11], v224, s[76:79], s93 offen offset:1024
buffer_load_dwordx4 a[12:15], v225, s[76:79], s93 offen offset:1024
v_exp_f32 v199, v199
v_fma_f32 v194, v194, v208, v208
ds_read_b128 v[64:67], v3 offset:22528
s_waitcnt lgkmcnt(4)
v_mfma_f32_32x32x16_bf16 v[32:47], v[68:71], v[144:147], v[32:47]
v_rcp_f32 v192, v192
v_fma_f32 v195, v195, v208, v208
ds_read_b128 v[68:71], v3 offset:23552
v_mfma_f32_32x32x16_bf16 v[32:47], v[72:75], v[148:151], v[32:47]
v_rcp_f32 v193, v193
v_fma_f32 v196, v196, v208, v208
ds_read_b128 v[72:75], v3 offset:24576
v_mfma_f32_32x32x16_bf16 v[32:47], v[76:79], v[152:155], v[32:47]
v_rcp_f32 v194, v194
v_fma_f32 v197, v197, v208, v208
ds_read_b128 v[76:79], v3 offset:25600
v_mfma_f32_32x32x16_bf16 v[32:47], v[48:51], v[156:159], v[32:47]
buffer_load_dwordx4 v1, s[12:15], s37 offen offset:2048 lds
ds_read_b128 v[48:51], v3 offset:26624
s_waitcnt lgkmcnt(4)
v_mfma_f32_32x32x16_bf16 v[32:47], v[52:55], v[160:163], v[32:47]
v_rcp_f32 v195, v195
v_fma_f32 v198, v198, v208, v208
s_waitcnt vmcnt(14)
s_barrier
ds_read_b128 v[52:55], v4 offset:13312
v_mfma_f32_32x32x16_bf16 v[32:47], v[56:59], v[164:167], v[32:47]
v_rcp_f32 v196, v196
v_fma_f32 v199, v199, v208, v208
ds_read_b128 v[56:59], v2 offset:7168
v_mfma_f32_32x32x16_bf16 v[32:47], v[60:63], v[168:171], v[32:47]
v_rcp_f32 v197, v197
v_mul_f32 v192, v24, v192
ds_read_b128 v[60:63], v2 offset:8192
v_mfma_f32_32x32x16_bf16 v[32:47], v[64:67], v[172:175], v[32:47]
buffer_load_dwordx4 a[16:19], v224, s[76:79], s93 offen offset:2048
buffer_load_dwordx4 a[20:23], v225, s[76:79], s93 offen offset:2048
v_rcp_f32 v198, v198
v_mul_f32 v193, v25, v193
ds_read_b128 v[64:67], v2 offset:9216
s_waitcnt lgkmcnt(4)
v_mfma_f32_32x32x16_bf16 v[32:47], v[68:71], v[176:179], v[32:47]
v_rcp_f32 v199, v199
v_mul_f32 v194, v26, v194
ds_read_b128 v[68:71], v2 offset:10240
v_mfma_f32_32x32x16_bf16 v[32:47], v[72:75], v[180:183], v[32:47]
v_mul_f32 v195, v27, v195
v_mul_f32 v196, v28, v196
v_mul_f32 v197, v29, v197
ds_read_b128 v[72:75], v2 offset:11264
v_mfma_f32_32x32x16_bf16 v[32:47], v[76:79], v[184:187], v[32:47]
v_mul_f32 v198, v30, v198
v_mul_f32 v199, v31, v199
v_cvt_pk_bf16_f32 v200, v192, v193
ds_read_b128 v[76:79], v2 offset:12288
v_mfma_f32_32x32x16_bf16 v[32:47], v[48:51], v[188:191], v[32:47]
v_cvt_pk_bf16_f32 v201, v194, v195
v_cvt_pk_bf16_f32 v202, v196, v197
v_cvt_pk_bf16_f32 v203, v198, v199
ds_read_b128 v[48:51], v2 offset:13312
s_waitcnt lgkmcnt(4)
v_mfma_f32_32x32x16_bf16 v[32:47], v[52:55], v[212:215], v[32:47]
s_add_u32 s42, s31, 0
buffer_store_dwordx4 v[200:203], v1, s[16:19], s42 offen sc1
ds_read_b128 v[52:55], v2 offset:35840
v_mfma_f32_32x32x16_bf16 v[16:31], v[56:59], v[80:83], 0
s_add_u32 s37, s46, 118784
s_add_u32 s38, s30, 21504
s_mov_b32 m0, s38
s_nop 0
buffer_load_dwordx4 v1, s[12:15], s37 offen offset:0 lds
ds_read_b128 v[56:59], v2 offset:36864
v_mfma_f32_32x32x16_bf16 v[16:31], v[60:63], v[84:87], v[16:31]
buffer_load_dwordx4 v1, s[12:15], s37 offen offset:1024 lds
ds_read_b128 v[60:63], v2 offset:37888
v_mfma_f32_32x32x16_bf16 v[16:31], v[64:67], v[88:91], v[16:31]
buffer_load_dwordx4 a[24:27], v224, s[76:79], s93 offen offset:3072
buffer_load_dwordx4 a[28:31], v225, s[76:79], s93 offen offset:3072
ds_read_b128 v[64:67], v2 offset:38912
s_waitcnt lgkmcnt(4)
v_mfma_f32_32x32x16_bf16 v[16:31], v[68:71], v[92:95], v[16:31]
buffer_load_dwordx4 v1, s[12:15], s37 offen offset:2048 lds
ds_read_b128 v[68:71], v2 offset:39936
v_mfma_f32_32x32x16_bf16 v[16:31], v[72:75], v[96:99], v[16:31]
buffer_load_dwordx4 v1, s[12:15], s37 offen offset:3072 lds
ds_read_b128 v[72:75], v2 offset:40960
v_mfma_f32_32x32x16_bf16 v[16:31], v[76:79], v[100:103], v[16:31]
v_mul_f32 v192, v32, v206
v_mul_f32 v193, v33, v206
v_mul_f32 v194, v34, v206
ds_read_b128 v[76:79], v2 offset:41984
v_mfma_f32_32x32x16_bf16 v[16:31], v[48:51], v[104:107], v[16:31]
v_exp_f32 v192, v192
v_mul_f32 v195, v35, v206
ds_read_b128 v[48:51], v2 offset:64512
s_waitcnt lgkmcnt(4)
v_mfma_f32_32x32x16_bf16 v[16:31], v[52:55], v[108:111], v[16:31]
v_exp_f32 v193, v193
v_mul_f32 v196, v36, v206
ds_read_b128 v[52:55], v3 offset:0
v_mfma_f32_32x32x16_bf16 v[16:31], v[56:59], v[112:115], v[16:31]
v_exp_f32 v194, v194
v_mul_f32 v197, v37, v206
ds_read_b128 v[56:59], v3 offset:1024
v_mfma_f32_32x32x16_bf16 v[16:31], v[60:63], v[116:119], v[16:31]
s_add_u32 s38, s38, 4096
s_mov_b32 m0, s38
s_add_u32 s37, s37, 4096
buffer_load_dwordx4 v1, s[12:15], s37 offen offset:0 lds
ds_read_b128 v[60:63], v3 offset:2048
v_mfma_f32_32x32x16_bf16 v[16:31], v[64:67], v[120:123], v[16:31]
s_mov_b32 s93, 4096
buffer_load_dwordx4 a[32:35], v224, s[76:79], s93 offen offset:0
buffer_load_dwordx4 a[36:39], v225, s[76:79], s93 offen offset:0
v_exp_f32 v195, v195
v_mul_f32 v198, v38, v206
ds_read_b128 v[64:67], v3 offset:3072
s_waitcnt lgkmcnt(4)
v_mfma_f32_32x32x16_bf16 v[16:31], v[68:71], v[124:127], v[16:31]
v_exp_f32 v196, v196
v_mul_f32 v199, v39, v206
ds_read_b128 v[68:71], v3 offset:4096
v_mfma_f32_32x32x16_bf16 v[16:31], v[72:75], v[128:131], v[16:31]
v_exp_f32 v197, v197
v_fma_f32 v192, v192, v208, v208
ds_read_b128 v[72:75], v3 offset:5120
v_mfma_f32_32x32x16_bf16 v[16:31], v[76:79], v[132:135], v[16:31]
v_exp_f32 v198, v198
v_fma_f32 v193, v193, v208, v208
ds_read_b128 v[76:79], v3 offset:27648
v_mfma_f32_32x32x16_bf16 v[16:31], v[48:51], v[136:139], v[16:31]
buffer_load_dwordx4 v1, s[12:15], s37 offen offset:1024 lds
ds_read_b128 v[48:51], v3 offset:28672
s_waitcnt lgkmcnt(4)
v_mfma_f32_32x32x16_bf16 v[16:31], v[52:55], v[140:143], v[16:31]
v_exp_f32 v199, v199
v_fma_f32 v194, v194, v208, v208
ds_read_b128 v[52:55], v3 offset:29696
v_mfma_f32_32x32x16_bf16 v[16:31], v[56:59], v[144:147], v[16:31]
v_rcp_f32 v192, v192
v_fma_f32 v195, v195, v208, v208
ds_read_b128 v[56:59], v3 offset:30720
v_mfma_f32_32x32x16_bf16 v[16:31], v[60:63], v[148:151], v[16:31]
v_rcp_f32 v193, v193
v_fma_f32 v196, v196, v208, v208
ds_read_b128 v[60:63], v3 offset:31744
v_mfma_f32_32x32x16_bf16 v[16:31], v[64:67], v[152:155], v[16:31]
buffer_load_dwordx4 a[40:43], v224, s[76:79], s93 offen offset:1024
buffer_load_dwordx4 a[44:47], v225, s[76:79], s93 offen offset:1024
v_rcp_f32 v194, v194
v_fma_f32 v197, v197, v208, v208
ds_read_b128 v[64:67], v3 offset:32768
s_waitcnt lgkmcnt(4)
v_mfma_f32_32x32x16_bf16 v[16:31], v[68:71], v[156:159], v[16:31]
buffer_load_dwordx4 v1, s[12:15], s37 offen offset:2048 lds
ds_read_b128 v[68:71], v3 offset:33792
v_mfma_f32_32x32x16_bf16 v[16:31], v[72:75], v[160:163], v[16:31]
v_rcp_f32 v195, v195
v_fma_f32 v198, v198, v208, v208
s_waitcnt vmcnt(16)
s_barrier
ds_read_b128 v[72:75], v4 offset:14336
v_mfma_f32_32x32x16_bf16 v[16:31], v[76:79], v[164:167], v[16:31]
v_rcp_f32 v196, v196
v_fma_f32 v199, v199, v208, v208
ds_read_b128 v[76:79], v2 offset:14336
v_mfma_f32_32x32x16_bf16 v[16:31], v[48:51], v[168:171], v[16:31]
v_rcp_f32 v197, v197
v_mul_f32 v192, v40, v192
ds_read_b128 v[48:51], v2 offset:15360
s_waitcnt lgkmcnt(4)
v_mfma_f32_32x32x16_bf16 v[16:31], v[52:55], v[172:175], v[16:31]
v_rcp_f32 v198, v198
v_mul_f32 v193, v41, v193
ds_read_b128 v[52:55], v2 offset:16384
v_mfma_f32_32x32x16_bf16 v[16:31], v[56:59], v[176:179], v[16:31]
v_rcp_f32 v199, v199
v_mul_f32 v194, v42, v194
ds_read_b128 v[56:59], v2 offset:17408
v_mfma_f32_32x32x16_bf16 v[16:31], v[60:63], v[180:183], v[16:31]
v_mul_f32 v195, v43, v195
v_mul_f32 v196, v44, v196
v_mul_f32 v197, v45, v197
ds_read_b128 v[60:63], v2 offset:18432
v_mfma_f32_32x32x16_bf16 v[16:31], v[64:67], v[184:187], v[16:31]
buffer_load_dwordx4 a[48:51], v224, s[76:79], s93 offen offset:2048
buffer_load_dwordx4 a[52:55], v225, s[76:79], s93 offen offset:2048
v_mul_f32 v198, v46, v198
v_mul_f32 v199, v47, v199
v_cvt_pk_bf16_f32 v200, v192, v193
ds_read_b128 v[64:67], v2 offset:19456
s_waitcnt lgkmcnt(4)
v_mfma_f32_32x32x16_bf16 v[16:31], v[68:71], v[188:191], v[16:31]
v_cvt_pk_bf16_f32 v201, v194, v195
v_cvt_pk_bf16_f32 v202, v196, v197
v_cvt_pk_bf16_f32 v203, v198, v199
ds_read_b128 v[68:71], v2 offset:20480
v_mfma_f32_32x32x16_bf16 v[16:31], v[72:75], v[212:215], v[16:31]
s_add_u32 s42, s31, 1024
buffer_store_dwordx4 v[200:203], v1, s[16:19], s42 offen sc1
ds_read_b128 v[72:75], v2 offset:43008
v_mfma_f32_32x32x16_bf16 v[32:47], v[76:79], v[80:83], 0
s_add_u32 s37, s46, 148480
s_add_u32 s38, s36, 114688
s_mov_b32 m0, s38
s_nop 0
buffer_load_dwordx4 v1, s[12:15], s37 offen offset:0 lds
ds_read_b128 v[76:79], v2 offset:44032
v_mfma_f32_32x32x16_bf16 v[32:47], v[48:51], v[84:87], v[32:47]
buffer_load_dwordx4 v1, s[12:15], s37 offen offset:1024 lds
ds_read_b128 v[48:51], v2 offset:45056
s_waitcnt lgkmcnt(4)
v_mfma_f32_32x32x16_bf16 v[32:47], v[52:55], v[88:91], v[32:47]
ds_read_b128 v[52:55], v2 offset:46080
v_mfma_f32_32x32x16_bf16 v[32:47], v[56:59], v[92:95], v[32:47]
buffer_load_dwordx4 v1, s[12:15], s37 offen offset:2048 lds
ds_read_b128 v[56:59], v2 offset:47104
v_mfma_f32_32x32x16_bf16 v[32:47], v[60:63], v[96:99], v[32:47]
buffer_load_dwordx4 v1, s[12:15], s37 offen offset:3072 lds
ds_read_b128 v[60:63], v2 offset:48128
v_mfma_f32_32x32x16_bf16 v[32:47], v[64:67], v[100:103], v[32:47]
buffer_load_dwordx4 a[56:59], v224, s[76:79], s93 offen offset:3072
buffer_load_dwordx4 a[60:63], v225, s[76:79], s93 offen offset:3072
v_mul_f32 v192, v16, v206
v_mul_f32 v193, v17, v206
v_mul_f32 v194, v18, v206
ds_read_b128 v[64:67], v2 offset:49152
s_waitcnt lgkmcnt(4)
v_mfma_f32_32x32x16_bf16 v[32:47], v[68:71], v[104:107], v[32:47]
v_exp_f32 v192, v192
v_mul_f32 v195, v19, v206
ds_read_b128 v[68:71], v3 offset:6144
v_mfma_f32_32x32x16_bf16 v[32:47], v[72:75], v[108:111], v[32:47]
v_exp_f32 v193, v193
v_mul_f32 v196, v20, v206
ds_read_b128 v[72:75], v3 offset:7168
v_mfma_f32_32x32x16_bf16 v[32:47], v[76:79], v[112:115], v[32:47]
v_exp_f32 v194, v194
v_mul_f32 v197, v21, v206
ds_read_b128 v[76:79], v3 offset:8192
v_mfma_f32_32x32x16_bf16 v[32:47], v[48:51], v[116:119], v[32:47]
s_add_u32 s38, s38, 4096
s_mov_b32 m0, s38
s_add_u32 s37, s37, 4096
buffer_load_dwordx4 v1, s[12:15], s37 offen offset:0 lds
ds_read_b128 v[48:51], v3 offset:9216
s_waitcnt lgkmcnt(4)
v_mfma_f32_32x32x16_bf16 v[32:47], v[52:55], v[120:123], v[32:47]
v_exp_f32 v195, v195
v_mul_f32 v198, v22, v206
ds_read_b128 v[52:55], v3 offset:10240
v_mfma_f32_32x32x16_bf16 v[32:47], v[56:59], v[124:127], v[32:47]
v_exp_f32 v196, v196
v_mul_f32 v199, v23, v206
ds_read_b128 v[56:59], v3 offset:11264
v_mfma_f32_32x32x16_bf16 v[32:47], v[60:63], v[128:131], v[32:47]
v_exp_f32 v197, v197
v_fma_f32 v192, v192, v208, v208
ds_read_b128 v[60:63], v3 offset:12288
v_mfma_f32_32x32x16_bf16 v[32:47], v[64:67], v[132:135], v[32:47]
s_mov_b32 s93, 8192
buffer_load_dwordx4 a[64:67], v224, s[76:79], s93 offen offset:0
buffer_load_dwordx4 a[68:71], v225, s[76:79], s93 offen offset:0
v_exp_f32 v198, v198
v_fma_f32 v193, v193, v208, v208
ds_read_b128 v[64:67], v3 offset:34816
s_waitcnt lgkmcnt(4)
v_mfma_f32_32x32x16_bf16 v[32:47], v[68:71], v[136:139], v[32:47]
buffer_load_dwordx4 v1, s[12:15], s37 offen offset:1024 lds
ds_read_b128 v[68:71], v3 offset:35840
v_mfma_f32_32x32x16_bf16 v[32:47], v[72:75], v[140:143], v[32:47]
v_exp_f32 v199, v199
v_fma_f32 v194, v194, v208, v208
ds_read_b128 v[72:75], v3 offset:36864
v_mfma_f32_32x32x16_bf16 v[32:47], v[76:79], v[144:147], v[32:47]
v_rcp_f32 v192, v192
v_fma_f32 v195, v195, v208, v208
ds_read_b128 v[76:79], v3 offset:37888
v_mfma_f32_32x32x16_bf16 v[32:47], v[48:51], v[148:151], v[32:47]
v_rcp_f32 v193, v193
v_fma_f32 v196, v196, v208, v208
ds_read_b128 v[48:51], v3 offset:38912
s_waitcnt lgkmcnt(4)
v_mfma_f32_32x32x16_bf16 v[32:47], v[52:55], v[152:155], v[32:47]
v_rcp_f32 v194, v194
v_fma_f32 v197, v197, v208, v208
ds_read_b128 v[52:55], v3 offset:39936
v_mfma_f32_32x32x16_bf16 v[32:47], v[56:59], v[156:159], v[32:47]
buffer_load_dwordx4 v1, s[12:15], s37 offen offset:2048 lds
ds_read_b128 v[56:59], v3 offset:40960
v_mfma_f32_32x32x16_bf16 v[32:47], v[60:63], v[160:163], v[32:47]
v_rcp_f32 v195, v195
v_fma_f32 v198, v198, v208, v208
s_waitcnt vmcnt(14)
s_barrier
ds_read_b128 v[60:63], v4 offset:15360
v_mfma_f32_32x32x16_bf16 v[32:47], v[64:67], v[164:167], v[32:47]
buffer_load_dwordx4 a[72:75], v224, s[76:79], s93 offen offset:1024
buffer_load_dwordx4 a[76:79], v225, s[76:79], s93 offen offset:1024
v_rcp_f32 v196, v196
v_fma_f32 v199, v199, v208, v208
ds_read_b128 v[64:67], v2 offset:21504
s_waitcnt lgkmcnt(4)
v_mfma_f32_32x32x16_bf16 v[32:47], v[68:71], v[168:171], v[32:47]
v_rcp_f32 v197, v197
v_mul_f32 v192, v24, v192
ds_read_b128 v[68:71], v2 offset:22528
v_mfma_f32_32x32x16_bf16 v[32:47], v[72:75], v[172:175], v[32:47]
v_rcp_f32 v198, v198
v_mul_f32 v193, v25, v193
ds_read_b128 v[72:75], v2 offset:23552
v_mfma_f32_32x32x16_bf16 v[32:47], v[76:79], v[176:179], v[32:47]
v_rcp_f32 v199, v199
v_mul_f32 v194, v26, v194
ds_read_b128 v[76:79], v2 offset:24576
v_mfma_f32_32x32x16_bf16 v[32:47], v[48:51], v[180:183], v[32:47]
v_mul_f32 v195, v27, v195
v_mul_f32 v196, v28, v196
v_mul_f32 v197, v29, v197
ds_read_b128 v[48:51], v2 offset:25600
s_waitcnt lgkmcnt(4)
v_mfma_f32_32x32x16_bf16 v[32:47], v[52:55], v[184:187], v[32:47]
v_mul_f32 v198, v30, v198
v_mul_f32 v199, v31, v199
v_cvt_pk_bf16_f32 v200, v192, v193
ds_read_b128 v[52:55], v2 offset:26624
v_mfma_f32_32x32x16_bf16 v[32:47], v[56:59], v[188:191], v[32:47]
v_cvt_pk_bf16_f32 v201, v194, v195
v_cvt_pk_bf16_f32 v202, v196, v197
v_cvt_pk_bf16_f32 v203, v198, v199
ds_read_b128 v[56:59], v2 offset:27648
v_mfma_f32_32x32x16_bf16 v[32:47], v[60:63], v[212:215], v[32:47]
s_add_u32 s42, s31, 2048
buffer_store_dwordx4 v[200:203], v1, s[16:19], s42 offen sc1
ds_read_b128 v[60:63], v2 offset:50176
v_mfma_f32_32x32x16_bf16 v[16:31], v[64:67], v[80:83], 0
buffer_load_dwordx4 a[80:83], v224, s[76:79], s93 offen offset:2048
buffer_load_dwordx4 a[84:87], v225, s[76:79], s93 offen offset:2048
s_add_u32 s37, s46, 178176
s_add_u32 s38, s30, 0
s_mov_b32 m0, s38
s_nop 0
buffer_load_dwordx4 v1, s[12:15], s37 offen offset:0 lds
ds_read_b128 v[64:67], v2 offset:51200
s_waitcnt lgkmcnt(4)
v_mfma_f32_32x32x16_bf16 v[16:31], v[68:71], v[84:87], v[16:31]
buffer_load_dwordx4 v1, s[12:15], s37 offen offset:1024 lds
ds_read_b128 v[68:71], v2 offset:52224
v_mfma_f32_32x32x16_bf16 v[16:31], v[72:75], v[88:91], v[16:31]
ds_read_b128 v[72:75], v2 offset:53248
v_mfma_f32_32x32x16_bf16 v[16:31], v[76:79], v[92:95], v[16:31]
buffer_load_dwordx4 v1, s[12:15], s37 offen offset:2048 lds
ds_read_b128 v[76:79], v2 offset:54272
v_mfma_f32_32x32x16_bf16 v[16:31], v[48:51], v[96:99], v[16:31]
buffer_load_dwordx4 v1, s[12:15], s37 offen offset:3072 lds
ds_read_b128 v[48:51], v2 offset:55296
s_waitcnt lgkmcnt(4)
v_mfma_f32_32x32x16_bf16 v[16:31], v[52:55], v[100:103], v[16:31]
v_mul_f32 v192, v32, v206
v_mul_f32 v193, v33, v206
v_mul_f32 v194, v34, v206
ds_read_b128 v[52:55], v2 offset:56320
v_mfma_f32_32x32x16_bf16 v[16:31], v[56:59], v[104:107], v[16:31]
v_exp_f32 v192, v192
v_mul_f32 v195, v35, v206
ds_read_b128 v[56:59], v3 offset:13312
v_mfma_f32_32x32x16_bf16 v[16:31], v[60:63], v[108:111], v[16:31]
v_exp_f32 v193, v193
v_mul_f32 v196, v36, v206
ds_read_b128 v[60:63], v3 offset:14336
v_mfma_f32_32x32x16_bf16 v[16:31], v[64:67], v[112:115], v[16:31]
buffer_load_dwordx4 a[88:91], v224, s[76:79], s93 offen offset:3072
buffer_load_dwordx4 a[92:95], v225, s[76:79], s93 offen offset:3072
v_exp_f32 v194, v194
v_mul_f32 v197, v37, v206
ds_read_b128 v[64:67], v3 offset:15360
s_waitcnt lgkmcnt(4)
v_mfma_f32_32x32x16_bf16 v[16:31], v[68:71], v[116:119], v[16:31]
s_add_u32 s38, s38, 4096
s_mov_b32 m0, s38
s_add_u32 s37, s37, 4096
buffer_load_dwordx4 v1, s[12:15], s37 offen offset:0 lds
ds_read_b128 v[68:71], v3 offset:16384
v_mfma_f32_32x32x16_bf16 v[16:31], v[72:75], v[120:123], v[16:31]
v_exp_f32 v195, v195
v_mul_f32 v198, v38, v206
ds_read_b128 v[72:75], v3 offset:17408
v_mfma_f32_32x32x16_bf16 v[16:31], v[76:79], v[124:127], v[16:31]
v_exp_f32 v196, v196
v_mul_f32 v199, v39, v206
ds_read_b128 v[76:79], v3 offset:18432
v_mfma_f32_32x32x16_bf16 v[16:31], v[48:51], v[128:131], v[16:31]
v_exp_f32 v197, v197
v_fma_f32 v192, v192, v208, v208
ds_read_b128 v[48:51], v3 offset:19456
s_waitcnt lgkmcnt(4)
v_mfma_f32_32x32x16_bf16 v[16:31], v[52:55], v[132:135], v[16:31]
v_exp_f32 v198, v198
v_fma_f32 v193, v193, v208, v208
ds_read_b128 v[52:55], v3 offset:41984
v_mfma_f32_32x32x16_bf16 v[16:31], v[56:59], v[136:139], v[16:31]
buffer_load_dwordx4 v1, s[12:15], s37 offen offset:1024 lds
ds_read_b128 v[56:59], v3 offset:43008
v_mfma_f32_32x32x16_bf16 v[16:31], v[60:63], v[140:143], v[16:31]
v_exp_f32 v199, v199
v_fma_f32 v194, v194, v208, v208
ds_read_b128 v[60:63], v3 offset:44032
v_mfma_f32_32x32x16_bf16 v[16:31], v[64:67], v[144:147], v[16:31]
s_mov_b32 s93, 12288
buffer_load_dwordx4 a[96:99], v224, s[76:79], s93 offen offset:0
buffer_load_dwordx4 a[100:103], v225, s[76:79], s93 offen offset:0
v_rcp_f32 v192, v192
v_fma_f32 v195, v195, v208, v208
ds_read_b128 v[64:67], v3 offset:45056
s_waitcnt lgkmcnt(4)
v_mfma_f32_32x32x16_bf16 v[16:31], v[68:71], v[148:151], v[16:31]
v_rcp_f32 v193, v193
v_fma_f32 v196, v196, v208, v208
ds_read_b128 v[68:71], v3 offset:46080
v_mfma_f32_32x32x16_bf16 v[16:31], v[72:75], v[152:155], v[16:31]
v_rcp_f32 v194, v194
v_fma_f32 v197, v197, v208, v208
ds_read_b128 v[72:75], v3 offset:47104
v_mfma_f32_32x32x16_bf16 v[16:31], v[76:79], v[156:159], v[16:31]
buffer_load_dwordx4 v1, s[12:15], s37 offen offset:2048 lds
ds_read_b128 v[76:79], v3 offset:48128
v_mfma_f32_32x32x16_bf16 v[16:31], v[48:51], v[160:163], v[16:31]
v_rcp_f32 v195, v195
v_fma_f32 v198, v198, v208, v208
s_waitcnt vmcnt(16)
s_barrier
ds_read_b128 v[48:51], v4 offset:16384
s_waitcnt lgkmcnt(4)
v_mfma_f32_32x32x16_bf16 v[16:31], v[52:55], v[164:167], v[16:31]
v_rcp_f32 v196, v196
v_fma_f32 v199, v199, v208, v208
ds_read_b128 v[52:55], v3 offset:49152
v_mfma_f32_32x32x16_bf16 v[16:31], v[56:59], v[168:171], v[16:31]
v_rcp_f32 v197, v197
v_mul_f32 v192, v40, v192
ds_read_b128 v[56:59], v3 offset:50176
v_mfma_f32_32x32x16_bf16 v[16:31], v[60:63], v[172:175], v[16:31]
v_rcp_f32 v198, v198
v_mul_f32 v193, v41, v193
ds_read_b128 v[60:63], v3 offset:51200
v_mfma_f32_32x32x16_bf16 v[16:31], v[64:67], v[176:179], v[16:31]
buffer_load_dwordx4 a[104:107], v224, s[76:79], s93 offen offset:1024
buffer_load_dwordx4 a[108:111], v225, s[76:79], s93 offen offset:1024
v_rcp_f32 v199, v199
v_mul_f32 v194, v42, v194
ds_read_b128 v[64:67], v3 offset:52224
s_waitcnt lgkmcnt(4)
v_mfma_f32_32x32x16_bf16 v[16:31], v[68:71], v[180:183], v[16:31]
v_mul_f32 v195, v43, v195
v_mul_f32 v196, v44, v196
v_mul_f32 v197, v45, v197
ds_read_b128 v[68:71], v3 offset:53248
v_mfma_f32_32x32x16_bf16 v[16:31], v[72:75], v[184:187], v[16:31]
v_mul_f32 v198, v46, v198
v_mul_f32 v199, v47, v199
v_cvt_pk_bf16_f32 v200, v192, v193
ds_read_b128 v[72:75], v3 offset:54272
v_mfma_f32_32x32x16_bf16 v[16:31], v[76:79], v[188:191], v[16:31]
v_cvt_pk_bf16_f32 v201, v194, v195
v_cvt_pk_bf16_f32 v202, v196, v197
v_cvt_pk_bf16_f32 v203, v198, v199
ds_read_b128 v[76:79], v3 offset:55296
v_mfma_f32_32x32x16_bf16 v[16:31], v[48:51], v[212:215], v[16:31]
s_add_u32 s42, s31, 3072
buffer_store_dwordx4 v[200:203], v1, s[16:19], s42 offen sc1
ds_read_b128 v[48:51], v3 offset:56320
s_waitcnt lgkmcnt(4)
v_mfma_f32_32x32x16_bf16 v[32:47], v[52:55], v[80:83], 0
ds_read_b128 v[52:55], v3 offset:57344
v_mfma_f32_32x32x16_bf16 v[32:47], v[56:59], v[84:87], v[32:47]
ds_read_b128 v[56:59], v3 offset:58368
v_mfma_f32_32x32x16_bf16 v[32:47], v[60:63], v[88:91], v[32:47]
ds_read_b128 v[60:63], v3 offset:59392
v_mfma_f32_32x32x16_bf16 v[32:47], v[64:67], v[92:95], v[32:47]
buffer_load_dwordx4 a[112:115], v224, s[76:79], s93 offen offset:2048
buffer_load_dwordx4 a[116:119], v225, s[76:79], s93 offen offset:2048
ds_read_b128 v[64:67], v3 offset:60416
s_waitcnt lgkmcnt(4)
v_mfma_f32_32x32x16_bf16 v[32:47], v[68:71], v[96:99], v[32:47]
ds_read_b128 v[68:71], v3 offset:61440
v_mfma_f32_32x32x16_bf16 v[32:47], v[72:75], v[100:103], v[32:47]
v_mul_f32 v192, v16, v206
v_mul_f32 v193, v17, v206
v_mul_f32 v194, v18, v206
ds_read_b128 v[72:75], v3 offset:62464
v_mfma_f32_32x32x16_bf16 v[32:47], v[76:79], v[104:107], v[32:47]
v_exp_f32 v192, v192
v_mul_f32 v195, v19, v206
ds_read_b128 v[76:79], v3 offset:63488
v_mfma_f32_32x32x16_bf16 v[32:47], v[48:51], v[108:111], v[32:47]
v_exp_f32 v193, v193
v_mul_f32 v196, v20, v206
ds_read_b128 v[48:51], v3 offset:64512
s_waitcnt lgkmcnt(4)
v_mfma_f32_32x32x16_bf16 v[32:47], v[52:55], v[112:115], v[32:47]
v_exp_f32 v194, v194
v_mul_f32 v197, v21, v206
ds_read_b128 v[52:55], v4 offset:0
v_mfma_f32_32x32x16_bf16 v[32:47], v[56:59], v[116:119], v[32:47]
v_exp_f32 v195, v195
v_mul_f32 v198, v22, v206
ds_read_b128 v[56:59], v4 offset:1024
v_mfma_f32_32x32x16_bf16 v[32:47], v[60:63], v[120:123], v[32:47]
v_exp_f32 v196, v196
v_mul_f32 v199, v23, v206
ds_read_b128 v[60:63], v4 offset:2048
v_mfma_f32_32x32x16_bf16 v[32:47], v[64:67], v[124:127], v[32:47]
buffer_load_dwordx4 a[120:123], v224, s[76:79], s93 offen offset:3072
buffer_load_dwordx4 a[124:127], v225, s[76:79], s93 offen offset:3072
v_exp_f32 v197, v197
v_fma_f32 v192, v192, v208, v208
ds_read_b128 v[64:67], v4 offset:3072
s_waitcnt lgkmcnt(4)
v_mfma_f32_32x32x16_bf16 v[32:47], v[68:71], v[128:131], v[32:47]
v_exp_f32 v198, v198
v_fma_f32 v193, v193, v208, v208
ds_read_b128 v[68:71], v4 offset:4096
v_mfma_f32_32x32x16_bf16 v[32:47], v[72:75], v[132:135], v[32:47]
v_exp_f32 v199, v199
v_fma_f32 v194, v194, v208, v208
ds_read_b128 v[72:75], v4 offset:5120
v_mfma_f32_32x32x16_bf16 v[32:47], v[76:79], v[136:139], v[32:47]
v_rcp_f32 v192, v192
v_fma_f32 v195, v195, v208, v208
ds_read_b128 v[76:79], v4 offset:6144
v_mfma_f32_32x32x16_bf16 v[32:47], v[48:51], v[140:143], v[32:47]
v_rcp_f32 v193, v193
v_fma_f32 v196, v196, v208, v208
ds_read_b128 v[48:51], v4 offset:7168
s_waitcnt lgkmcnt(4)
v_mfma_f32_32x32x16_bf16 v[32:47], v[52:55], v[144:147], v[32:47]
v_rcp_f32 v194, v194
v_fma_f32 v197, v197, v208, v208
ds_read_b128 v[52:55], v4 offset:8192
v_mfma_f32_32x32x16_bf16 v[32:47], v[56:59], v[148:151], v[32:47]
v_rcp_f32 v195, v195
v_fma_f32 v198, v198, v208, v208
ds_read_b128 v[56:59], v4 offset:9216
v_mfma_f32_32x32x16_bf16 v[32:47], v[60:63], v[152:155], v[32:47]
v_rcp_f32 v196, v196
v_fma_f32 v199, v199, v208, v208
ds_read_b128 v[60:63], v4 offset:10240
v_mfma_f32_32x32x16_bf16 v[32:47], v[64:67], v[156:159], v[32:47]
s_mov_b32 s93, 16384
buffer_load_dwordx4 a[128:131], v224, s[76:79], s93 offen offset:0
buffer_load_dwordx4 a[132:135], v225, s[76:79], s93 offen offset:0
v_rcp_f32 v197, v197
v_mul_f32 v192, v24, v192
ds_read_b128 v[64:67], v4 offset:11264
s_waitcnt lgkmcnt(4)
v_mfma_f32_32x32x16_bf16 v[32:47], v[68:71], v[160:163], v[32:47]
v_rcp_f32 v198, v198
v_mul_f32 v193, v25, v193
s_waitcnt vmcnt(9)
s_barrier
ds_read_b128 v[68:71], v4 offset:17408
v_mfma_f32_32x32x16_bf16 v[32:47], v[72:75], v[164:167], v[32:47]
v_rcp_f32 v199, v199
v_mul_f32 v194, v26, v194
ds_read_b128 v[72:75], v2 offset:0
v_mfma_f32_32x32x16_bf16 v[32:47], v[76:79], v[168:171], v[32:47]
v_mul_f32 v195, v27, v195
v_mul_f32 v196, v28, v196
v_mul_f32 v197, v29, v197
ds_read_b128 v[76:79], v2 offset:1024
v_mfma_f32_32x32x16_bf16 v[32:47], v[48:51], v[172:175], v[32:47]
v_mul_f32 v198, v30, v198
v_mul_f32 v199, v31, v199
v_cvt_pk_bf16_f32 v200, v192, v193
ds_read_b128 v[48:51], v2 offset:2048
s_waitcnt lgkmcnt(4)
v_mfma_f32_32x32x16_bf16 v[32:47], v[52:55], v[176:179], v[32:47]
v_cvt_pk_bf16_f32 v201, v194, v195
v_cvt_pk_bf16_f32 v202, v196, v197
v_cvt_pk_bf16_f32 v203, v198, v199
ds_read_b128 v[52:55], v2 offset:3072
v_mfma_f32_32x32x16_bf16 v[32:47], v[56:59], v[180:183], v[32:47]
s_add_u32 s42, s31, 4096
buffer_store_dwordx4 v[200:203], v1, s[16:19], s42 offen sc1
ds_read_b128 v[56:59], v2 offset:4096
v_mfma_f32_32x32x16_bf16 v[32:47], v[60:63], v[184:187], v[32:47]
ds_read_b128 v[60:63], v2 offset:5120
v_mfma_f32_32x32x16_bf16 v[32:47], v[64:67], v[188:191], v[32:47]
buffer_load_dwordx4 a[136:139], v224, s[76:79], s93 offen offset:1024
buffer_load_dwordx4 a[140:143], v225, s[76:79], s93 offen offset:1024
ds_read_b128 v[64:67], v2 offset:6144
s_waitcnt lgkmcnt(4)
v_mfma_f32_32x32x16_bf16 v[32:47], v[68:71], v[212:215], v[32:47]
ds_read_b128 v[68:71], v2 offset:28672
v_mfma_f32_32x32x16_bf16 v[16:31], v[72:75], v[80:83], 0
ds_read_b128 v[72:75], v2 offset:29696
v_mfma_f32_32x32x16_bf16 v[16:31], v[76:79], v[84:87], v[16:31]
ds_read_b128 v[76:79], v2 offset:30720
v_mfma_f32_32x32x16_bf16 v[16:31], v[48:51], v[88:91], v[16:31]
ds_read_b128 v[48:51], v2 offset:31744
s_waitcnt lgkmcnt(4)
v_mfma_f32_32x32x16_bf16 v[16:31], v[52:55], v[92:95], v[16:31]
ds_read_b128 v[52:55], v2 offset:32768
v_mfma_f32_32x32x16_bf16 v[16:31], v[56:59], v[96:99], v[16:31]
ds_read_b128 v[56:59], v2 offset:33792
v_mfma_f32_32x32x16_bf16 v[16:31], v[60:63], v[100:103], v[16:31]
v_mul_f32 v192, v32, v206
v_mul_f32 v193, v33, v206
v_mul_f32 v194, v34, v206
ds_read_b128 v[60:63], v2 offset:34816
v_mfma_f32_32x32x16_bf16 v[16:31], v[64:67], v[104:107], v[16:31]
buffer_load_dwordx4 a[144:147], v224, s[76:79], s93 offen offset:2048
buffer_load_dwordx4 a[148:151], v225, s[76:79], s93 offen offset:2048
v_exp_f32 v192, v192
v_mul_f32 v195, v35, v206
ds_read_b128 v[64:67], v2 offset:57344
s_waitcnt lgkmcnt(4)
v_mfma_f32_32x32x16_bf16 v[16:31], v[68:71], v[108:111], v[16:31]
v_exp_f32 v193, v193
v_mul_f32 v196, v36, v206
ds_read_b128 v[68:71], v2 offset:58368
v_mfma_f32_32x32x16_bf16 v[16:31], v[72:75], v[112:115], v[16:31]
v_exp_f32 v194, v194
v_mul_f32 v197, v37, v206
ds_read_b128 v[72:75], v2 offset:59392
v_mfma_f32_32x32x16_bf16 v[16:31], v[76:79], v[116:119], v[16:31]
v_exp_f32 v195, v195
v_mul_f32 v198, v38, v206
ds_read_b128 v[76:79], v2 offset:60416
v_mfma_f32_32x32x16_bf16 v[16:31], v[48:51], v[120:123], v[16:31]
v_exp_f32 v196, v196
v_mul_f32 v199, v39, v206
ds_read_b128 v[48:51], v2 offset:61440
s_waitcnt lgkmcnt(4)
v_mfma_f32_32x32x16_bf16 v[16:31], v[52:55], v[124:127], v[16:31]
v_exp_f32 v197, v197
v_fma_f32 v192, v192, v208, v208
ds_read_b128 v[52:55], v2 offset:62464
v_mfma_f32_32x32x16_bf16 v[16:31], v[56:59], v[128:131], v[16:31]
v_exp_f32 v198, v198
v_fma_f32 v193, v193, v208, v208
ds_read_b128 v[56:59], v2 offset:63488
v_mfma_f32_32x32x16_bf16 v[16:31], v[60:63], v[132:135], v[16:31]
v_exp_f32 v199, v199
v_fma_f32 v194, v194, v208, v208
ds_read_b128 v[60:63], v3 offset:20480
v_mfma_f32_32x32x16_bf16 v[16:31], v[64:67], v[136:139], v[16:31]
buffer_load_dwordx4 a[152:155], v224, s[76:79], s93 offen offset:3072
buffer_load_dwordx4 a[156:159], v225, s[76:79], s93 offen offset:3072
v_rcp_f32 v192, v192
v_fma_f32 v195, v195, v208, v208
ds_read_b128 v[64:67], v3 offset:21504
s_waitcnt lgkmcnt(4)
v_mfma_f32_32x32x16_bf16 v[16:31], v[68:71], v[140:143], v[16:31]
v_rcp_f32 v193, v193
v_fma_f32 v196, v196, v208, v208
ds_read_b128 v[68:71], v3 offset:22528
v_mfma_f32_32x32x16_bf16 v[16:31], v[72:75], v[144:147], v[16:31]
v_rcp_f32 v194, v194
v_fma_f32 v197, v197, v208, v208
ds_read_b128 v[72:75], v3 offset:23552
v_mfma_f32_32x32x16_bf16 v[16:31], v[76:79], v[148:151], v[16:31]
v_rcp_f32 v195, v195
v_fma_f32 v198, v198, v208, v208
ds_read_b128 v[76:79], v3 offset:24576
v_mfma_f32_32x32x16_bf16 v[16:31], v[48:51], v[152:155], v[16:31]
v_rcp_f32 v196, v196
v_fma_f32 v199, v199, v208, v208
ds_read_b128 v[48:51], v3 offset:25600
s_waitcnt lgkmcnt(4)
v_mfma_f32_32x32x16_bf16 v[16:31], v[52:55], v[156:159], v[16:31]
v_rcp_f32 v197, v197
v_mul_f32 v192, v40, v192
ds_read_b128 v[52:55], v3 offset:26624
v_mfma_f32_32x32x16_bf16 v[16:31], v[56:59], v[160:163], v[16:31]
v_rcp_f32 v198, v198
v_mul_f32 v193, v41, v193
ds_read_b128 v[56:59], v4 offset:18432
v_mfma_f32_32x32x16_bf16 v[16:31], v[60:63], v[164:167], v[16:31]
v_rcp_f32 v199, v199
v_mul_f32 v194, v42, v194
v_mfma_f32_32x32x16_bf16 v[16:31], v[64:67], v[168:171], v[16:31]
v_mul_f32 v195, v43, v195
v_mul_f32 v196, v44, v196
v_mul_f32 v197, v45, v197
s_waitcnt lgkmcnt(2)
v_mfma_f32_32x32x16_bf16 v[16:31], v[68:71], v[172:175], v[16:31]
v_mul_f32 v198, v46, v198
v_mul_f32 v199, v47, v199
v_cvt_pk_bf16_f32 v200, v192, v193
v_mfma_f32_32x32x16_bf16 v[16:31], v[72:75], v[176:179], v[16:31]
v_cvt_pk_bf16_f32 v201, v194, v195
v_cvt_pk_bf16_f32 v202, v196, v197
v_cvt_pk_bf16_f32 v203, v198, v199
v_mfma_f32_32x32x16_bf16 v[16:31], v[76:79], v[180:183], v[16:31]
s_add_u32 s42, s31, 5120
buffer_store_dwordx4 v[200:203], v1, s[16:19], s42 offen sc1
v_mfma_f32_32x32x16_bf16 v[16:31], v[48:51], v[184:187], v[16:31]
s_waitcnt lgkmcnt(0)
v_mfma_f32_32x32x16_bf16 v[16:31], v[52:55], v[188:191], v[16:31]
v_mfma_f32_32x32x16_bf16 v[16:31], v[56:59], v[212:215], v[16:31]
s_nop 7
s_nop 7
v_mul_f32 v192, v16, v206
v_mul_f32 v193, v17, v206
v_mul_f32 v194, v18, v206
v_mul_f32 v195, v19, v206
v_mul_f32 v196, v20, v206
v_mul_f32 v197, v21, v206
v_mul_f32 v198, v22, v206
v_mul_f32 v199, v23, v206
v_exp_f32 v192, v192
v_exp_f32 v193, v193
v_exp_f32 v194, v194
v_exp_f32 v195, v195
v_exp_f32 v196, v196
v_exp_f32 v197, v197
v_exp_f32 v198, v198
v_exp_f32 v199, v199
v_fma_f32 v192, v192, v208, v208
v_fma_f32 v193, v193, v208, v208
v_fma_f32 v194, v194, v208, v208
v_fma_f32 v195, v195, v208, v208
v_fma_f32 v196, v196, v208, v208
v_fma_f32 v197, v197, v208, v208
v_fma_f32 v198, v198, v208, v208
v_fma_f32 v199, v199, v208, v208
v_rcp_f32 v192, v192
v_rcp_f32 v193, v193
v_rcp_f32 v194, v194
v_rcp_f32 v195, v195
v_rcp_f32 v196, v196
v_rcp_f32 v197, v197
v_rcp_f32 v198, v198
v_rcp_f32 v199, v199
v_mul_f32 v192, v24, v192
v_mul_f32 v193, v25, v193
v_mul_f32 v194, v26, v194
v_mul_f32 v195, v27, v195
v_mul_f32 v196, v28, v196
v_mul_f32 v197, v29, v197
v_mul_f32 v198, v30, v198
v_mul_f32 v199, v31, v199
v_cvt_pk_bf16_f32 v200, v192, v193
v_cvt_pk_bf16_f32 v201, v194, v195
v_cvt_pk_bf16_f32 v202, v196, v197
v_cvt_pk_bf16_f32 v203, v198, v199
s_add_u32 s42, s31, 6144
buffer_store_dwordx4 v[200:203], v1, s[16:19], s42 offen sc1
s_mov_b32 s84, s4
s_mov_b32 s85, s5
s_mov_b32 s86, 65536
s_mov_b32 s87, 0x00020000
buffer_load_dword v10, off, s[84:87], 0 sc1
s_cmp_ge_u32 s26, 28
s_cbranch_scc0 LF_work
s_waitcnt vmcnt(0)
s_barrier
s_cmp_eq_u32 s24, 0
s_cbranch_scc0 LF_nfa
s_lshl_b32 s53, s27, 4
s_add_u32 s53, s53, s28
s_lshl_b32 s53, s53, 6
s_add_u32 s53, s53, 24576
v_mov_b32 v12, 0
s_mov_b64 exec, 1
buffer_store_dword v10, v12, s[84:87], s53 offen sc1
s_mov_b64 exec, -1
LF_nfa:
s_branch LF_end
LF_work:
s_mov_b32 s80, s6
s_mov_b32 s81, s7
s_mov_b32 s82, 1835008
s_mov_b32 s83, 0x00020000
s_mov_b32 s93, 20480
buffer_load_dwordx4 a[160:163], v224, s[76:79], s93 offen offset:0
buffer_load_dwordx4 a[164:167], v225, s[76:79], s93 offen offset:0
buffer_load_dwordx4 a[168:171], v224, s[76:79], s93 offen offset:1024
buffer_load_dwordx4 a[172:175], v225, s[76:79], s93 offen offset:1024
s_waitcnt vmcnt(4)
s_barrier
s_cmp_eq_u32 s24, 0
s_cbranch_scc0 LF_nfb
s_lshl_b32 s53, s27, 4
s_add_u32 s53, s53, s28
s_lshl_b32 s53, s53, 6
s_add_u32 s53, s53, 24576
v_mov_b32 v12, 0
s_mov_b64 exec, 1
buffer_store_dword v10, v12, s[84:87], s53 offen sc1
s_mov_b64 exec, -1
LF_nfb:
buffer_load_dwordx4 a[176:179], v224, s[76:79], s93 offen offset:2048
buffer_load_dwordx4 a[180:183], v225, s[76:79], s93 offen offset:2048
buffer_load_dwordx4 a[184:187], v224, s[76:79], s93 offen offset:3072
buffer_load_dwordx4 a[188:191], v225, s[76:79], s93 offen offset:3072
s_mov_b32 s93, 24576
buffer_load_dwordx4 a[192:195], v224, s[76:79], s93 offen offset:0
buffer_load_dwordx4 a[196:199], v225, s[76:79], s93 offen offset:0
buffer_load_dwordx4 a[200:203], v224, s[76:79], s93 offen offset:1024
buffer_load_dwordx4 a[204:207], v225, s[76:79], s93 offen offset:1024
buffer_load_dwordx4 a[208:211], v224, s[76:79], s93 offen offset:2048
buffer_load_dwordx4 a[212:215], v225, s[76:79], s93 offen offset:2048
buffer_load_dwordx4 a[216:219], v224, s[76:79], s93 offen offset:3072
buffer_load_dwordx4 a[220:223], v225, s[76:79], s93 offen offset:3072
s_and_b32 s50, s24, 1
s_lshl_b32 s50, s50, 5
s_lshl_b32 s51, s44, 6
s_add_u32 s50, s50, s51
v_and_b32 v11, 31, v0
v_add_u32 v11, s50, v11
v_mul_u32_u24 v11, 896, v11
s_lshr_b32 s51, s24, 1
s_lshl_b32 s51, s51, 5
s_lshl_b32 s52, s45, 6
s_add_u32 s51, s51, s52
s_lshl_b32 s51, s51, 1
v_lshrrev_b32 v12, 5, v0
v_lshlrev_b32 v12, 3, v12
v_add_u32 v11, v11, v12
v_add_u32 v2, s51, v11
s_waitcnt vmcnt(0)
s_cmp_eq_u32 s24, 0
s_cbranch_scc0 LF_nopoll
s_lshr_b32 s50, s44, 1
s_lshl_b32 s50, s50, 10
s_add_u32 s50, s50, 24576
v_and_b32 v9, 15, v0
v_lshlrev_b32 v9, 6, v9
s_mov_b32 s51, 0
LF_poll:
buffer_load_dword v11, v9, s[84:87], s50 offen sc1
s_waitcnt vmcnt(0)
v_cmp_ne_u32 vcc, v11, v10
s_cbranch_vccz LF_nopoll
s_add_u32 s51, s51, 1
s_cmp_lt_u32 s51, 0x80000
s_cbranch_scc1 LF_poll
LF_nopoll:
s_barrier
s_mov_b32 s94, 0
buffer_load_dwordx4 v[80:83], v226, s[16:19], s94 offen offset:0
buffer_load_dwordx4 v[84:87], v227, s[16:19], s94 offen offset:0
buffer_load_dwordx4 v[88:91], v226, s[16:19], s94 offen offset:1024
buffer_load_dwordx4 v[92:95], v227, s[16:19], s94 offen offset:1024
buffer_load_dwordx4 v[96:99], v226, s[16:19], s94 offen offset:2048
buffer_load_dwordx4 v[100:103], v227, s[16:19], s94 offen offset:2048
buffer_load_dwordx4 v[104:107], v226, s[16:19], s94 offen offset:3072
buffer_load_dwordx4 v[108:111], v227, s[16:19], s94 offen offset:3072
s_mov_b32 s94, 4096
buffer_load_dwordx4 v[112:115], v226, s[16:19], s94 offen offset:0
buffer_load_dwordx4 v[116:119], v227, s[16:19], s94 offen offset:0
buffer_load_dwordx4 v[120:123], v226, s[16:19], s94 offen offset:1024
buffer_load_dwordx4 v[124:127], v227, s[16:19], s94 offen offset:1024
buffer_load_dwordx4 v[128:131], v226, s[16:19], s94 offen offset:2048
buffer_load_dwordx4 v[132:135], v227, s[16:19], s94 offen offset:2048
buffer_load_dwordx4 v[136:139], v226, s[16:19], s94 offen offset:3072
buffer_load_dwordx4 v[140:143], v227, s[16:19], s94 offen offset:3072
buffer_load_dwordx2 v[208:209], v2, s[20:23], 0 offen offset:0 sc1
buffer_load_dwordx2 v[210:211], v2, s[20:23], 0 offen offset:16 sc1
buffer_load_dwordx2 v[212:213], v2, s[20:23], 0 offen offset:32 sc1
buffer_load_dwordx2 v[214:215], v2, s[20:23], 0 offen offset:48 sc1
s_waitcnt vmcnt(18)
v_mfma_f32_32x32x16_bf16 v[16:31], a[0:3], v[80:83], 0
v_mfma_f32_32x32x16_bf16 v[32:47], a[0:3], v[84:87], 0
v_mfma_f32_32x32x16_bf16 v[48:63], a[4:7], v[80:83], 0
v_mfma_f32_32x32x16_bf16 v[64:79], a[4:7], v[84:87], 0
s_mov_b32 s94, 8192
buffer_load_dwordx4 v[80:83], v226, s[16:19], s94 offen offset:0
buffer_load_dwordx4 v[84:87], v227, s[16:19], s94 offen offset:0
s_waitcnt vmcnt(18)
v_mfma_f32_32x32x16_bf16 v[16:31], a[8:11], v[88:91], v[16:31]
v_mfma_f32_32x32x16_bf16 v[32:47], a[8:11], v[92:95], v[32:47]
v_mfma_f32_32x32x16_bf16 v[48:63], a[12:15], v[88:91], v[48:63]
v_mfma_f32_32x32x16_bf16 v[64:79], a[12:15], v[92:95], v[64:79]
buffer_load_dwordx4 v[88:91], v226, s[16:19], s94 offen offset:1024
buffer_load_dwordx4 v[92:95], v227, s[16:19], s94 offen offset:1024
s_waitcnt vmcnt(18)
v_mfma_f32_32x32x16_bf16 v[16:31], a[16:19], v[96:99], v[16:31]
v_mfma_f32_32x32x16_bf16 v[32:47], a[16:19], v[100:103], v[32:47]
v_mfma_f32_32x32x16_bf16 v[48:63], a[20:23], v[96:99], v[48:63]
v_mfma_f32_32x32x16_bf16 v[64:79], a[20:23], v[100:103], v[64:79]
buffer_load_dwordx4 v[96:99], v226, s[16:19], s94 offen offset:2048
buffer_load_dwordx4 v[100:103], v227, s[16:19], s94 offen offset:2048
s_waitcnt vmcnt(18)
v_mfma_f32_32x32x16_bf16 v[16:31], a[24:27], v[104:107], v[16:31]
v_mfma_f32_32x32x16_bf16 v[32:47], a[24:27], v[108:111], v[32:47]
v_mfma_f32_32x32x16_bf16 v[48:63], a[28:31], v[104:107], v[48:63]
v_mfma_f32_32x32x16_bf16 v[64:79], a[28:31], v[108:111], v[64:79]
buffer_load_dwordx4 v[104:107], v226, s[16:19], s94 offen offset:3072
buffer_load_dwordx4 v[108:111], v227, s[16:19], s94 offen offset:3072
s_waitcnt vmcnt(18)
v_mfma_f32_32x32x16_bf16 v[16:31], a[32:35], v[112:115], v[16:31]
v_mfma_f32_32x32x16_bf16 v[32:47], a[32:35], v[116:119], v[32:47]
v_mfma_f32_32x32x16_bf16 v[48:63], a[36:39], v[112:115], v[48:63]
v_mfma_f32_32x32x16_bf16 v[64:79], a[36:39], v[116:119], v[64:79]
s_mov_b32 s94, 12288
buffer_load_dwordx4 v[112:115], v226, s[16:19], s94 offen offset:0
buffer_load_dwordx4 v[116:119], v227, s[16:19], s94 offen offset:0
s_waitcnt vmcnt(18)
v_mfma_f32_32x32x16_bf16 v[16:31], a[40:43], v[120:123], v[16:31]
v_mfma_f32_32x32x16_bf16 v[32:47], a[40:43], v[124:127], v[32:47]
v_mfma_f32_32x32x16_bf16 v[48:63], a[44:47], v[120:123], v[48:63]
v_mfma_f32_32x32x16_bf16 v[64:79], a[44:47], v[124:127], v[64:79]
buffer_load_dwordx4 v[120:123], v226, s[16:19], s94 offen offset:1024
buffer_load_dwordx4 v[124:127], v227, s[16:19], s94 offen offset:1024
s_waitcnt vmcnt(18)
v_mfma_f32_32x32x16_bf16 v[16:31], a[48:51], v[128:131], v[16:31]
v_mfma_f32_32x32x16_bf16 v[32:47], a[48:51], v[132:135], v[32:47]
v_mfma_f32_32x32x16_bf16 v[48:63], a[52:55], v[128:131], v[48:63]
v_mfma_f32_32x32x16_bf16 v[64:79], a[52:55], v[132:135], v[64:79]
buffer_load_dwordx4 v[128:131], v226, s[16:19], s94 offen offset:2048
buffer_load_dwordx4 v[132:135], v227, s[16:19], s94 offen offset:2048
s_waitcnt vmcnt(18)
v_mfma_f32_32x32x16_bf16 v[16:31], a[56:59], v[136:139], v[16:31]
v_mfma_f32_32x32x16_bf16 v[32:47], a[56:59], v[140:143], v[32:47]
v_mfma_f32_32x32x16_bf16 v[48:63], a[60:63], v[136:139], v[48:63]
v_mfma_f32_32x32x16_bf16 v[64:79], a[60:63], v[140:143], v[64:79]
buffer_load_dwordx4 v[136:139], v226, s[16:19], s94 offen offset:3072
buffer_load_dwordx4 v[140:143], v227, s[16:19], s94 offen offset:3072
s_waitcnt vmcnt(14)
v_mfma_f32_32x32x16_bf16 v[16:31], a[64:67], v[80:83], v[16:31]
v_mfma_f32_32x32x16_bf16 v[32:47], a[64:67], v[84:87], v[32:47]
v_mfma_f32_32x32x16_bf16 v[48:63], a[68:71], v[80:83], v[48:63]
v_mfma_f32_32x32x16_bf16 v[64:79], a[68:71], v[84:87], v[64:79]
s_mov_b32 s94, 16384
buffer_load_dwordx4 v[80:83], v226, s[16:19], s94 offen offset:0
buffer_load_dwordx4 v[84:87], v227, s[16:19], s94 offen offset:0
s_waitcnt vmcnt(14)
v_mfma_f32_32x32x16_bf16 v[16:31], a[72:75], v[88:91], v[16:31]
v_mfma_f32_32x32x16_bf16 v[32:47], a[72:75], v[92:95], v[32:47]
v_mfma_f32_32x32x16_bf16 v[48:63], a[76:79], v[88:91], v[48:63]
v_mfma_f32_32x32x16_bf16 v[64:79], a[76:79], v[92:95], v[64:79]
buffer_load_dwordx4 v[88:91], v226, s[16:19], s94 offen offset:1024
buffer_load_dwordx4 v[92:95], v227, s[16:19], s94 offen offset:1024
s_waitcnt vmcnt(14)
v_mfma_f32_32x32x16_bf16 v[16:31], a[80:83], v[96:99], v[16:31]
v_mfma_f32_32x32x16_bf16 v[32:47], a[80:83], v[100:103], v[32:47]
v_mfma_f32_32x32x16_bf16 v[48:63], a[84:87], v[96:99], v[48:63]
v_mfma_f32_32x32x16_bf16 v[64:79], a[84:87], v[100:103], v[64:79]
buffer_load_dwordx4 v[96:99], v226, s[16:19], s94 offen offset:2048
buffer_load_dwordx4 v[100:103], v227, s[16:19], s94 offen offset:2048
s_waitcnt vmcnt(14)
v_mfma_f32_32x32x16_bf16 v[16:31], a[88:91], v[104:107], v[16:31]
v_mfma_f32_32x32x16_bf16 v[32:47], a[88:91], v[108:111], v[32:47]
v_mfma_f32_32x32x16_bf16 v[48:63], a[92:95], v[104:107], v[48:63]
v_mfma_f32_32x32x16_bf16 v[64:79], a[92:95], v[108:111], v[64:79]
buffer_load_dwordx4 v[104:107], v226, s[16:19], s94 offen offset:3072
buffer_load_dwordx4 v[108:111], v227, s[16:19], s94 offen offset:3072
s_waitcnt vmcnt(14)
v_mfma_f32_32x32x16_bf16 v[16:31], a[96:99], v[112:115], v[16:31]
v_mfma_f32_32x32x16_bf16 v[32:47], a[96:99], v[116:119], v[32:47]
v_mfma_f32_32x32x16_bf16 v[48:63], a[100:103], v[112:115], v[48:63]
v_mfma_f32_32x32x16_bf16 v[64:79], a[100:103], v[116:119], v[64:79]
s_mov_b32 s94, 20480
buffer_load_dwordx4 v[112:115], v226, s[16:19], s94 offen offset:0
buffer_load_dwordx4 v[116:119], v227, s[16:19], s94 offen offset:0
s_waitcnt vmcnt(14)
v_mfma_f32_32x32x16_bf16 v[16:31], a[104:107], v[120:123], v[16:31]
v_mfma_f32_32x32x16_bf16 v[32:47], a[104:107], v[124:127], v[32:47]
v_mfma_f32_32x32x16_bf16 v[48:63], a[108:111], v[120:123], v[48:63]
v_mfma_f32_32x32x16_bf16 v[64:79], a[108:111], v[124:127], v[64:79]
buffer_load_dwordx4 v[120:123], v226, s[16:19], s94 offen offset:1024
buffer_load_dwordx4 v[124:127], v227, s[16:19], s94 offen offset:1024
s_waitcnt vmcnt(14)
v_mfma_f32_32x32x16_bf16 v[16:31], a[112:115], v[128:131], v[16:31]
v_mfma_f32_32x32x16_bf16 v[32:47], a[112:115], v[132:135], v[32:47]
v_mfma_f32_32x32x16_bf16 v[48:63], a[116:119], v[128:131], v[48:63]
v_mfma_f32_32x32x16_bf16 v[64:79], a[116:119], v[132:135], v[64:79]
buffer_load_dwordx4 v[128:131], v226, s[16:19], s94 offen offset:2048
buffer_load_dwordx4 v[132:135], v227, s[16:19], s94 offen offset:2048
s_waitcnt vmcnt(14)
v_mfma_f32_32x32x16_bf16 v[16:31], a[120:123], v[136:139], v[16:31]
v_mfma_f32_32x32x16_bf16 v[32:47], a[120:123], v[140:143], v[32:47]
v_mfma_f32_32x32x16_bf16 v[48:63], a[124:127], v[136:139], v[48:63]
v_mfma_f32_32x32x16_bf16 v[64:79], a[124:127], v[140:143], v[64:79]
buffer_load_dwordx4 v[136:139], v226, s[16:19], s94 offen offset:3072
buffer_load_dwordx4 v[140:143], v227, s[16:19], s94 offen offset:3072
s_waitcnt vmcnt(14)
v_mfma_f32_32x32x16_bf16 v[16:31], a[128:131], v[80:83], v[16:31]
v_mfma_f32_32x32x16_bf16 v[32:47], a[128:131], v[84:87], v[32:47]
v_mfma_f32_32x32x16_bf16 v[48:63], a[132:135], v[80:83], v[48:63]
v_mfma_f32_32x32x16_bf16 v[64:79], a[132:135], v[84:87], v[64:79]
s_mov_b32 s94, 24576
buffer_load_dwordx4 v[80:83], v226, s[16:19], s94 offen offset:0
buffer_load_dwordx4 v[84:87], v227, s[16:19], s94 offen offset:0
s_waitcnt vmcnt(14)
v_mfma_f32_32x32x16_bf16 v[16:31], a[136:139], v[88:91], v[16:31]
v_mfma_f32_32x32x16_bf16 v[32:47], a[136:139], v[92:95], v[32:47]
v_mfma_f32_32x32x16_bf16 v[48:63], a[140:143], v[88:91], v[48:63]
v_mfma_f32_32x32x16_bf16 v[64:79], a[140:143], v[92:95], v[64:79]
buffer_load_dwordx4 v[88:91], v226, s[16:19], s94 offen offset:1024
buffer_load_dwordx4 v[92:95], v227, s[16:19], s94 offen offset:1024
s_waitcnt vmcnt(14)
v_mfma_f32_32x32x16_bf16 v[16:31], a[144:147], v[96:99], v[16:31]
v_mfma_f32_32x32x16_bf16 v[32:47], a[144:147], v[100:103], v[32:47]
v_mfma_f32_32x32x16_bf16 v[48:63], a[148:151], v[96:99], v[48:63]
v_mfma_f32_32x32x16_bf16 v[64:79], a[148:151], v[100:103], v[64:79]
buffer_load_dwordx4 v[96:99], v226, s[16:19], s94 offen offset:2048
buffer_load_dwordx4 v[100:103], v227, s[16:19], s94 offen offset:2048
s_waitcnt vmcnt(14)
v_mfma_f32_32x32x16_bf16 v[16:31], a[152:155], v[104:107], v[16:31]
v_mfma_f32_32x32x16_bf16 v[32:47], a[152:155], v[108:111], v[32:47]
v_mfma_f32_32x32x16_bf16 v[48:63], a[156:159], v[104:107], v[48:63]
v_mfma_f32_32x32x16_bf16 v[64:79], a[156:159], v[108:111], v[64:79]
buffer_load_dwordx4 v[104:107], v226, s[16:19], s94 offen offset:3072
buffer_load_dwordx4 v[108:111], v227, s[16:19], s94 offen offset:3072
s_waitcnt vmcnt(14)
v_mfma_f32_32x32x16_bf16 v[16:31], a[160:163], v[112:115], v[16:31]
v_mfma_f32_32x32x16_bf16 v[32:47], a[160:163], v[116:119], v[32:47]
v_mfma_f32_32x32x16_bf16 v[48:63], a[164:167], v[112:115], v[48:63]
v_mfma_f32_32x32x16_bf16 v[64:79], a[164:167], v[116:119], v[64:79]
s_waitcnt vmcnt(12)
v_mfma_f32_32x32x16_bf16 v[16:31], a[168:171], v[120:123], v[16:31]
v_mfma_f32_32x32x16_bf16 v[32:47], a[168:171], v[124:127], v[32:47]
v_mfma_f32_32x32x16_bf16 v[48:63], a[172:175], v[120:123], v[48:63]
v_mfma_f32_32x32x16_bf16 v[64:79], a[172:175], v[124:127], v[64:79]
s_waitcnt vmcnt(10)
v_mfma_f32_32x32x16_bf16 v[16:31], a[176:179], v[128:131], v[16:31]
v_mfma_f32_32x32x16_bf16 v[32:47], a[176:179], v[132:135], v[32:47]
v_mfma_f32_32x32x16_bf16 v[48:63], a[180:183], v[128:131], v[48:63]
v_mfma_f32_32x32x16_bf16 v[64:79], a[180:183], v[132:135], v[64:79]
s_waitcnt vmcnt(8)
v_mfma_f32_32x32x16_bf16 v[16:31], a[184:187], v[136:139], v[16:31]
v_mfma_f32_32x32x16_bf16 v[32:47], a[184:187], v[140:143], v[32:47]
v_mfma_f32_32x32x16_bf16 v[48:63], a[188:191], v[136:139], v[48:63]
v_mfma_f32_32x32x16_bf16 v[64:79], a[188:191], v[140:143], v[64:79]
s_waitcnt vmcnt(6)
v_mfma_f32_32x32x16_bf16 v[16:31], a[192:195], v[80:83], v[16:31]
v_mfma_f32_32x32x16_bf16 v[32:47], a[192:195], v[84:87], v[32:47]
v_mfma_f32_32x32x16_bf16 v[48:63], a[196:199], v[80:83], v[48:63]
v_mfma_f32_32x32x16_bf16 v[64:79], a[196:199], v[84:87], v[64:79]
s_waitcnt vmcnt(4)
v_mfma_f32_32x32x16_bf16 v[16:31], a[200:203], v[88:91], v[16:31]
v_mfma_f32_32x32x16_bf16 v[32:47], a[200:203], v[92:95], v[32:47]
v_mfma_f32_32x32x16_bf16 v[48:63], a[204:207], v[88:91], v[48:63]
v_mfma_f32_32x32x16_bf16 v[64:79], a[204:207], v[92:95], v[64:79]
s_waitcnt vmcnt(2)
v_mfma_f32_32x32x16_bf16 v[16:31], a[208:211], v[96:99], v[16:31]
v_mfma_f32_32x32x16_bf16 v[32:47], a[208:211], v[100:103], v[32:47]
v_mfma_f32_32x32x16_bf16 v[48:63], a[212:215], v[96:99], v[48:63]
v_mfma_f32_32x32x16_bf16 v[64:79], a[212:215], v[100:103], v[64:79]
s_waitcnt vmcnt(0)
v_mfma_f32_32x32x16_bf16 v[16:31], a[216:219], v[104:107], v[16:31]
v_mfma_f32_32x32x16_bf16 v[32:47], a[216:219], v[108:111], v[32:47]
v_mfma_f32_32x32x16_bf16 v[48:63], a[220:223], v[104:107], v[48:63]
v_mfma_f32_32x32x16_bf16 v[64:79], a[220:223], v[108:111], v[64:79]
v_add_u32 v4, 0, v1
s_nop 7
s_nop 3
s_cmp_lt_u32 s24, 2
s_cbranch_scc0 LF_w23
s_cmp_eq_u32 s24, 0
s_cbranch_scc0 LF_w1
ds_write_b128 v4, v[32:35] offset:20480
ds_write_b128 v4, v[36:39] offset:21504
ds_write_b128 v4, v[40:43] offset:22528
ds_write_b128 v4, v[44:47] offset:23552
ds_write_b128 v4, v[48:51] offset:28672
ds_write_b128 v4, v[52:55] offset:29696
ds_write_b128 v4, v[56:59] offset:30720
ds_write_b128 v4, v[60:63] offset:31744
ds_write_b128 v4, v[64:67] offset:36864
ds_write_b128 v4, v[68:71] offset:37888
ds_write_b128 v4, v[72:75] offset:38912
ds_write_b128 v4, v[76:79] offset:39936
s_branch LF_sent
LF_w1:
ds_write_b128 v4, v[16:19] offset:0
ds_write_b128 v4, v[20:23] offset:1024
ds_write_b128 v4, v[24:27] offset:2048
ds_write_b128 v4, v[28:31] offset:3072
ds_write_b128 v4, v[48:51] offset:32768
ds_write_b128 v4, v[52:55] offset:33792
ds_write_b128 v4, v[56:59] offset:34816
ds_write_b128 v4, v[60:63] offset:35840
ds_write_b128 v4, v[64:67] offset:40960
ds_write_b128 v4, v[68:71] offset:41984
ds_write_b128 v4, v[72:75] offset:43008
ds_write_b128 v4, v[76:79] offset:44032
v_pk_mul_f32 v[16:17], v[32:33], 1.0 op_sel_hi:[1,0]
v_pk_mul_f32 v[18:19], v[34:35], 1.0 op_sel_hi:[1,0]
v_pk_mul_f32 v[20:21], v[36:37], 1.0 op_sel_hi:[1,0]
v_pk_mul_f32 v[22:23], v[38:39], 1.0 op_sel_hi:[1,0]
v_pk_mul_f32 v[24:25], v[40:41], 1.0 op_sel_hi:[1,0]
v_pk_mul_f32 v[26:27], v[42:43], 1.0 op_sel_hi:[1,0]
v_pk_mul_f32 v[28:29], v[44:45], 1.0 op_sel_hi:[1,0]
v_pk_mul_f32 v[30:31], v[46:47], 1.0 op_sel_hi:[1,0]
s_branch LF_sent
LF_w23:
s_cmp_eq_u32 s24, 2
s_cbranch_scc0 LF_w3
ds_write_b128 v4, v[16:19] offset:4096
ds_write_b128 v4, v[20:23] offset:5120
ds_write_b128 v4, v[24:27] offset:6144
ds_write_b128 v4, v[28:31] offset:7168
ds_write_b128 v4, v[32:35] offset:12288
ds_write_b128 v4, v[36:39] offset:13312
ds_write_b128 v4, v[40:43] offset:14336
ds_write_b128 v4, v[44:47] offset:15360
ds_write_b128 v4, v[64:67] offset:45056
ds_write_b128 v4, v[68:71] offset:46080
ds_write_b128 v4, v[72:75] offset:47104
ds_write_b128 v4, v[76:79] offset:48128
v_pk_mul_f32 v[16:17], v[48:49], 1.0 op_sel_hi:[1,0]
v_pk_mul_f32 v[18:19], v[50:51], 1.0 op_sel_hi:[1,0]
v_pk_mul_f32 v[20:21], v[52:53], 1.0 op_sel_hi:[1,0]
v_pk_mul_f32 v[22:23], v[54:55], 1.0 op_sel_hi:[1,0]
v_pk_mul_f32 v[24:25], v[56:57], 1.0 op_sel_hi:[1,0]
v_pk_mul_f32 v[26:27], v[58:59], 1.0 op_sel_hi:[1,0]
v_pk_mul_f32 v[28:29], v[60:61], 1.0 op_sel_hi:[1,0]
v_pk_mul_f32 v[30:31], v[62:63], 1.0 op_sel_hi:[1,0]
s_branch LF_sent
LF_w3:
ds_write_b128 v4, v[16:19] offset:8192
ds_write_b128 v4, v[20:23] offset:9216
ds_write_b128 v4, v[24:27] offset:10240
ds_write_b128 v4, v[28:31] offset:11264
ds_write_b128 v4, v[32:35] offset:16384
ds_write_b128 v4, v[36:39] offset:17408
ds_write_b128 v4, v[40:43] offset:18432
ds_write_b128 v4, v[44:47] offset:19456
ds_write_b128 v4, v[48:51] offset:24576
ds_write_b128 v4, v[52:55] offset:25600
ds_write_b128 v4, v[56:59] offset:26624
ds_write_b128 v4, v[60:63] offset:27648
v_pk_mul_f32 v[16:17], v[64:65], 1.0 op_sel_hi:[1,0]
v_pk_mul_f32 v[18:19], v[66:67], 1.0 op_sel_hi:[1,0]
v_pk_mul_f32 v[20:21], v[68:69], 1.0 op_sel_hi:[1,0]
v_pk_mul_f32 v[22:23], v[70:71], 1.0 op_sel_hi:[1,0]
v_pk_mul_f32 v[24:25], v[72:73], 1.0 op_sel_hi:[1,0]
v_pk_mul_f32 v[26:27], v[74:75], 1.0 op_sel_hi:[1,0]
v_pk_mul_f32 v[28:29], v[76:77], 1.0 op_sel_hi:[1,0]
v_pk_mul_f32 v[30:31], v[78:79], 1.0 op_sel_hi:[1,0]
LF_sent:
v_lshlrev_b32 v128, 16, v208
v_and_b32 v129, 0xffff0000, v208
v_lshlrev_b32 v130, 16, v209
v_and_b32 v131, 0xffff0000, v209
v_lshlrev_b32 v132, 16, v210
v_and_b32 v133, 0xffff0000, v210
v_lshlrev_b32 v134, 16, v211
v_and_b32 v135, 0xffff0000, v211
v_lshlrev_b32 v136, 16, v212
v_and_b32 v137, 0xffff0000, v212
v_lshlrev_b32 v138, 16, v213
v_and_b32 v139, 0xffff0000, v213
v_lshlrev_b32 v140, 16, v214
v_and_b32 v141, 0xffff0000, v214
v_lshlrev_b32 v142, 16, v215
v_and_b32 v143, 0xffff0000, v215
v_pk_add_f32 v[16:17], v[16:17], v[128:129]
v_pk_add_f32 v[18:19], v[18:19], v[130:131]
v_pk_add_f32 v[20:21], v[20:21], v[132:133]
v_pk_add_f32 v[22:23], v[22:23], v[134:135]
v_pk_add_f32 v[24:25], v[24:25], v[136:137]
v_pk_add_f32 v[26:27], v[26:27], v[138:139]
v_pk_add_f32 v[28:29], v[28:29], v[140:141]
v_pk_add_f32 v[30:31], v[30:31], v[142:143]
v_lshrrev_b32 v12, 5, v0
v_lshlrev_b32 v12, 3, v12
v_add_u32 v9, v2, v12
s_mul_i32 s37, s24, 12288
v_add_u32 v4, s37, v1
s_waitcnt lgkmcnt(0)
s_barrier
ds_read_b128 v[80:83], v4 offset:0
ds_read_b128 v[84:87], v4 offset:1024
ds_read_b128 v[88:91], v4 offset:2048
ds_read_b128 v[92:95], v4 offset:3072
ds_read_b128 v[96:99], v4 offset:4096
ds_read_b128 v[100:103], v4 offset:5120
ds_read_b128 v[104:107], v4 offset:6144
ds_read_b128 v[108:111], v4 offset:7168
ds_read_b128 v[112:115], v4 offset:8192
ds_read_b128 v[116:119], v4 offset:9216
ds_read_b128 v[120:123], v4 offset:10240
ds_read_b128 v[124:127], v4 offset:11264
s_waitcnt lgkmcnt(4)
v_pk_add_f32 v[80:81], v[80:81], v[96:97]
v_pk_add_f32 v[82:83], v[82:83], v[98:99]
v_pk_add_f32 v[84:85], v[84:85], v[100:101]
v_pk_add_f32 v[86:87], v[86:87], v[102:103]
v_pk_add_f32 v[88:89], v[88:89], v[104:105]
v_pk_add_f32 v[90:91], v[90:91], v[106:107]
v_pk_add_f32 v[92:93], v[92:93], v[108:109]
v_pk_add_f32 v[94:95], v[94:95], v[110:111]
v_pk_add_f32 v[16:17], v[16:17], v[80:81]
v_pk_add_f32 v[18:19], v[18:19], v[82:83]
v_pk_add_f32 v[20:21], v[20:21], v[84:85]
v_pk_add_f32 v[22:23], v[22:23], v[86:87]
v_pk_add_f32 v[24:25], v[24:25], v[88:89]
v_pk_add_f32 v[26:27], v[26:27], v[90:91]
v_pk_add_f32 v[28:29], v[28:29], v[92:93]
v_pk_add_f32 v[30:31], v[30:31], v[94:95]
s_waitcnt lgkmcnt(2)
v_pk_add_f32 v[16:17], v[16:17], v[112:113]
v_pk_add_f32 v[18:19], v[18:19], v[114:115]
v_pk_add_f32 v[20:21], v[20:21], v[116:117]
v_pk_add_f32 v[22:23], v[22:23], v[118:119]
v_cvt_pk_bf16_f32 v128, v16, v17
v_cvt_pk_bf16_f32 v129, v18, v19
v_cvt_pk_bf16_f32 v130, v20, v21
v_cvt_pk_bf16_f32 v131, v22, v23
s_nop 1
v_permlane32_swap_b32 v128, v130
v_permlane32_swap_b32 v129, v131
buffer_store_dwordx4 v[128:131], v9, s[80:83], 0 offen offset:0
s_waitcnt lgkmcnt(0)
v_pk_add_f32 v[24:25], v[24:25], v[120:121]
v_pk_add_f32 v[26:27], v[26:27], v[122:123]
v_pk_add_f32 v[28:29], v[28:29], v[124:125]
v_pk_add_f32 v[30:31], v[30:31], v[126:127]
v_cvt_pk_bf16_f32 v132, v24, v25
v_cvt_pk_bf16_f32 v133, v26, v27
v_cvt_pk_bf16_f32 v134, v28, v29
v_cvt_pk_bf16_f32 v135, v30, v31
s_nop 1
v_permlane32_swap_b32 v132, v134
v_permlane32_swap_b32 v133, v135
buffer_store_dwordx4 v[132:135], v9, s[80:83], 0 offen offset:32
LF_end:
LC_end:
s_endpgm
code_end:
s_endpgm
.section .rodata,"a"
.p2align 6
.amdhsa_kernel ssm_kernel
  .amdhsa_next_free_vgpr 256
  .amdhsa_next_free_sgpr 100
  .amdhsa_accum_offset 256
  .amdhsa_group_segment_fixed_size 0
  .amdhsa_kernarg_size 128
  .amdhsa_user_sgpr_count 2
  .amdhsa_user_sgpr_kernarg_segment_ptr 1
  .amdhsa_system_sgpr_workgroup_id_x 1
  .amdhsa_float_denorm_mode_32 3
.end_amdhsa_kernel

.p2align 6
.amdhsa_kernel ffn_kernel
  .amdhsa_next_free_vgpr 480
  .amdhsa_next_free_sgpr 96
  .amdhsa_accum_offset 256
  .amdhsa_group_segment_fixed_size 0
  .amdhsa_kernarg_size 128
  .amdhsa_user_sgpr_count 2
  .amdhsa_user_sgpr_kernarg_segment_ptr 1
  .amdhsa_system_sgpr_workgroup_id_x 1
  .amdhsa_float_denorm_mode_32 3
.end_amdhsa_kernel
```
